```python
import torch

def _softmax(x, axis=-1):
    return torch.softmax(x, dim=axis)
def _gelu(x):
    return torch.nn.functional.gelu(x, approximate="tanh")
def _silu(x):
    return torch.nn.functional.silu(x)
def _sigmoid(x):
    return torch.sigmoid(x)
def _layernorm(x, axis=-1, eps=1e-5):
    m = x.mean(dim=axis, keepdim=True)
    v = x.var(dim=axis, keepdim=True, unbiased=False)
    return (x - m) / torch.sqrt(v + eps)
def _scatter_add(tgt, idx, src, axis=0):
    return tgt.clone().index_add_(axis, idx, src)
def _segment_sum(src, seg, n):
    out = torch.zeros((n,) + src.shape[1:], dtype=src.dtype)
    return out.index_add_(0, seg, src)
def _pad(x, pw):
    flat = tuple(v for pair in reversed(pw) for v in pair)
    return torch.nn.functional.pad(x, flat)

kernel_name = 'standalone__weight_only_int_quip__prompt'

def setup_inputs():

    _w = (lambda a: (lambda t: t.to(torch.bfloat16) if t.is_floating_point() else t)(torch.as_tensor(a)))
    B, S, D, F = 1, 2048, 640, 1536
    G = -1 if -1 > 0 else D
    D = (D // G) * G
    ng = D // G
    bits = 8 if 8 > 0 else 4
    qmax = 1 << bits
    qw = torch.randint(0, qmax, (D, F)).to(torch.int32)
    U, _ = (lambda *_a, **_k: torch.linalg.qr(*[torch.as_tensor(_x).float() for _x in _a], **_k))((lambda *s: torch.randn(*s, dtype=torch.bfloat16) * 0.05)(D, D))
    V, _ = (lambda *_a, **_k: torch.linalg.qr(*[torch.as_tensor(_x).float() for _x in _a], **_k))((lambda *s: torch.randn(*s, dtype=torch.bfloat16) * 0.05)(F, F))
    return {
        "x": _w((lambda *s: torch.randn(*s, dtype=torch.bfloat16) * 0.05)(B, S, D)),
        "qw": _w(qw),
        "scales": _w(torch.abs((lambda *s: torch.randn(*s, dtype=torch.bfloat16) * 0.05)(ng, F)) * 0.02 + 0.005),
        "zeros": _w(torch.full((ng, F), qmax / 2.0, dtype=float)),
        "U": _w(U.to(float)),
        "V": _w(V.to(float)),
    }

def reference(x, qw, scales, zeros, U, V):
    B, S, D = x.shape
    ng, F = scales.shape
    G = D // ng
    s = (lambda x, n, axis: torch.repeat_interleave(x, n, dim=axis))(scales, G, axis=0)
    z = (lambda x, n, axis: torch.repeat_interleave(x, n, dim=axis))(zeros, G, axis=0)
    wq = ((lambda x, dt: x.to(dt))(qw, x.dtype) - z) * s
    xr = torch.einsum("bsd,de->bse", x, U)
    h  = torch.einsum("bse,ef->bsf", xr, wq)
    y  = torch.einsum("bsf,fg->bsg", h, V)
    return y
```

```asm
; @launch grid=(256,1,1) block=(512,1,1) lds=131200
.amdgcn_target "amdgcn-amd-amdhsa--gfx950"
.text
.globl standalone__weight_only_int_quip__prompt_kernel
.p2align 8
.type standalone__weight_only_int_quip__prompt_kernel,@function
standalone__weight_only_int_quip__prompt_kernel:
    s_cmp_ge_u32 s2, 256
    s_cbranch_scc1 L_end
    s_load_dwordx16 s[16:31], s[0:1], 0
    s_load_dwordx2 s[32:33], s[0:1], 64
    v_lshrrev_b32 v1, 6, v0
    v_and_b32 v0, 63, v0
    v_readfirstlane_b32 s4, v1
    s_and_b32 s5, s2, 7
    s_lshr_b32 s6, s2, 3
    s_mov_b32 s78, 0
    s_cmp_ge_u32 s6, 20
    s_cbranch_scc1 L1b
    s_mov_b32 s78, 1
    s_mul_i32 s7, s6, 52
    s_lshr_b32 s7, s7, 8
    s_mul_i32 s8, s7, 5
    s_sub_u32 s8, s6, s8
    s_and_b32 s9, s5, 1
    s_mul_i32 s9, s9, 5
    s_add_u32 s8, s8, s9
    s_lshr_b32 s9, s5, 1
    s_lshl_b32 s9, s9, 2
    s_add_u32 s7, s7, s9
    s_cmp_lt_u32 s4, 4
    s_cbranch_scc1 L1a_cons
    s_sub_u32 s11, s4, 4
    v_lshrrev_b32 v16, 4, v0
    v_and_b32 v17, 15, v0
    s_mul_i32 s12, s11, 192
    s_mul_i32 s13, s7, 192
    v_mov_b32 v31, 5
    v_add_u32 v18, s12, v0
    v_mul_u32_u24 v19, 5462, v18
    v_lshrrev_b32 v19, 16, v19
    v_mul_u32_u24 v28, 12, v19
    v_sub_u32 v28, v18, v28
    v_lshrrev_b32 v29, 1, v28
    v_bfe_u32 v30, v19, 3, 1
    v_sub_u32 v29, v29, v30
    v_cmp_gt_i32 vcc, 0, v29
    v_and_b32 v28, 1, v28
    v_mul_u32_u24 v19, 3072, v19
    v_cndmask_b32 v29, v29, v31, vcc
    v_lshl_add_u32 v19, v28, 4, v19
    v_lshl_add_u32 v19, v29, 5, v19
    v_add_u32 v24, s13, v19
    v_add_u32 v18, s12, v0
    v_add_u32 v18, 64, v18
    v_mul_u32_u24 v19, 5462, v18
    v_lshrrev_b32 v19, 16, v19
    v_mul_u32_u24 v28, 12, v19
    v_sub_u32 v28, v18, v28
    v_lshrrev_b32 v29, 1, v28
    v_bfe_u32 v30, v19, 3, 1
    v_sub_u32 v29, v29, v30
    v_cmp_gt_i32 vcc, 0, v29
    v_and_b32 v28, 1, v28
    v_mul_u32_u24 v19, 3072, v19
    v_cndmask_b32 v29, v29, v31, vcc
    v_lshl_add_u32 v19, v28, 4, v19
    v_lshl_add_u32 v19, v29, 5, v19
    v_add_u32 v25, s13, v19
    v_add_u32 v18, s12, v0
    v_add_u32 v18, 128, v18
    v_mul_u32_u24 v19, 5462, v18
    v_lshrrev_b32 v19, 16, v19
    v_mul_u32_u24 v28, 12, v19
    v_sub_u32 v28, v18, v28
    v_lshrrev_b32 v29, 1, v28
    v_bfe_u32 v30, v19, 3, 1
    v_sub_u32 v29, v29, v30
    v_cmp_gt_i32 vcc, 0, v29
    v_and_b32 v28, 1, v28
    v_mul_u32_u24 v19, 3072, v19
    v_cndmask_b32 v29, v29, v31, vcc
    v_lshl_add_u32 v19, v28, 4, v19
    v_lshl_add_u32 v19, v29, 5, v19
    v_add_u32 v26, s13, v19
    s_lshl_b32 s12, s8, 6
    s_lshl_b32 s13, s11, 4
    s_add_u32 s12, s12, s13
    v_add_u32 v18, s12, v16
    v_mul_u32_u24 v18, 6144, v18
    v_lshl_add_u32 v20, v17, 4, v18
    v_add_u32 v21, 24576, v20
    v_add_u32 v22, 49152, v20
    v_add_u32 v23, 73728, v20
    s_mul_i32 s12, s11, 3072
    s_add_u32 s12, s12, 49152
    s_lshl_b32 s35, s11, 11
    s_add_u32 s34, s35, 16384
    s_mul_i32 s15, s8, 196608
    s_add_u32 s15, s15, s35
    v_lshlrev_b32 v33, 4, v0
    s_waitcnt lgkmcnt(0)
    s_mov_b32 s40, s26
    s_and_b32 s41, s27, 0xffff
    s_mov_b32 s42, 4718592
    s_mov_b32 s43, 0x00020000
    s_mov_b32 s36, s18
    s_and_b32 s37, s19, 0xffff
    s_mov_b32 s38, 3932160
    s_mov_b32 s39, 0x00020000
    s_mov_b32 s14, 0
    s_add_u32 m0, s12, 0
    s_nop 0
    buffer_load_dwordx4 v24, s[40:43], s14 offen lds
    s_add_u32 m0, s12, 1024
    s_nop 0
    buffer_load_dwordx4 v25, s[40:43], s14 offen lds
    s_add_u32 m0, s12, 2048
    s_nop 0
    buffer_load_dwordx4 v26, s[40:43], s14 offen lds
    buffer_load_dwordx4 v[64:67], v20, s[36:39], 0 offen offset:0
    buffer_load_dwordx4 v[68:71], v21, s[36:39], 0 offen offset:0
    buffer_load_dwordx4 v[72:75], v22, s[36:39], 0 offen offset:0
    buffer_load_dwordx4 v[76:79], v23, s[36:39], 0 offen offset:0
    s_add_u32 s48, s32, 7340032
    s_addc_u32 s49, s33, 0
    s_and_b32 s49, s49, 0xffff
    s_mov_b32 s50, 1966080
    s_mov_b32 s51, 0x00020000
    s_lshl_b32 s9, s11, 11
    s_add_u32 s9, s9, 16384
    v_lshrrev_b32 v18, 1, v17
    v_lshrrev_b32 v19, 1, v16
    v_xor_b32 v18, v18, v19
    v_and_b32 v19, 1, v17
    v_lshlrev_b32 v19, 3, v19
    v_lshl_add_u32 v19, v16, 7, v19
    v_add_u32 v19, s9, v19
    v_xor_b32 v32, 0, v18
    v_lshl_add_u32 v28, v32, 4, v19
    v_xor_b32 v32, 2, v18
    v_lshl_add_u32 v29, v32, 4, v19
    v_add_u32 v29, 512, v29
    v_xor_b32 v32, 4, v18
    v_lshl_add_u32 v30, v32, 4, v19
    v_add_u32 v30, 1024, v30
    v_xor_b32 v32, 6, v18
    v_lshl_add_u32 v31, v32, 4, v19
    v_add_u32 v31, 1536, v31
    v_lshlrev_b32 v27, 4, v17
    s_mov_b32 s14, 196608
    s_add_u32 m0, s12, 12288
    s_nop 0
    buffer_load_dwordx4 v24, s[40:43], s14 offen lds
    s_add_u32 m0, s12, 13312
    s_nop 0
    buffer_load_dwordx4 v25, s[40:43], s14 offen lds
    s_add_u32 m0, s12, 14336
    s_nop 0
    buffer_load_dwordx4 v26, s[40:43], s14 offen lds
    buffer_load_dwordx4 v[80:83], v20, s[36:39], 0 offen offset:256
    buffer_load_dwordx4 v[84:87], v21, s[36:39], 0 offen offset:256
    buffer_load_dwordx4 v[88:91], v22, s[36:39], 0 offen offset:256
    buffer_load_dwordx4 v[92:95], v23, s[36:39], 0 offen offset:256
    s_barrier
    ds_read_b128 v[36:39], v27 offset:0
    ds_read_b128 v[40:43], v27 offset:8192
    s_waitcnt vmcnt(7)
    s_mov_b32 s14, 393216
    s_add_u32 m0, s12, 24576
    s_nop 0
    buffer_load_dwordx4 v24, s[40:43], s14 offen lds
    s_add_u32 m0, s12, 25600
    s_nop 0
    buffer_load_dwordx4 v25, s[40:43], s14 offen lds
    s_add_u32 m0, s12, 26624
    s_nop 0
    buffer_load_dwordx4 v26, s[40:43], s14 offen lds
    buffer_load_dwordx4 v[96:99], v20, s[36:39], 0 offen offset:512
    buffer_load_dwordx4 v[100:103], v21, s[36:39], 0 offen offset:512
    buffer_load_dwordx4 v[104:107], v22, s[36:39], 0 offen offset:512
    buffer_load_dwordx4 v[108:111], v23, s[36:39], 0 offen offset:512
    v_cvt_f32_i32 v64, v64
    v_cvt_f32_i32 v65, v65
    v_cvt_f32_i32 v66, v66
    v_cvt_f32_i32 v67, v67
    v_cvt_f32_i32 v68, v68
    v_cvt_f32_i32 v69, v69
    v_cvt_f32_i32 v70, v70
    v_cvt_f32_i32 v71, v71
    v_cvt_f32_i32 v72, v72
    v_cvt_f32_i32 v73, v73
    v_cvt_f32_i32 v74, v74
    v_cvt_f32_i32 v75, v75
    v_cvt_f32_i32 v76, v76
    v_cvt_f32_i32 v77, v77
    v_cvt_f32_i32 v78, v78
    v_cvt_f32_i32 v79, v79
    s_waitcnt lgkmcnt(0)
    v_fma_f32 v64, v64, v36, v40
    v_fma_f32 v65, v65, v37, v41
    v_fma_f32 v66, v66, v38, v42
    v_fma_f32 v67, v67, v39, v43
    v_cvt_pk_bf16_f32 v44, v64, v65
    v_cvt_pk_bf16_f32 v45, v66, v67
    ds_write_b64 v28, v[44:45] offset:0
    v_fma_f32 v68, v68, v36, v40
    v_fma_f32 v69, v69, v37, v41
    v_fma_f32 v70, v70, v38, v42
    v_fma_f32 v71, v71, v39, v43
    v_cvt_pk_bf16_f32 v46, v68, v69
    v_cvt_pk_bf16_f32 v47, v70, v71
    ds_write_b64 v29, v[46:47] offset:0
    v_fma_f32 v72, v72, v36, v40
    v_fma_f32 v73, v73, v37, v41
    v_fma_f32 v74, v74, v38, v42
    v_fma_f32 v75, v75, v39, v43
    v_cvt_pk_bf16_f32 v48, v72, v73
    v_cvt_pk_bf16_f32 v49, v74, v75
    ds_write_b64 v30, v[48:49] offset:0
    v_fma_f32 v76, v76, v36, v40
    v_fma_f32 v77, v77, v37, v41
    v_fma_f32 v78, v78, v38, v42
    v_fma_f32 v79, v79, v39, v43
    v_cvt_pk_bf16_f32 v50, v76, v77
    v_cvt_pk_bf16_f32 v51, v78, v79
    ds_write_b64 v31, v[50:51] offset:0
    ds_read_b128 v[36:39], v27 offset:256
    ds_read_b128 v[40:43], v27 offset:8448
    s_waitcnt lgkmcnt(2)
    s_barrier
    s_waitcnt vmcnt(7)
    s_mov_b32 s14, 589824
    s_add_u32 m0, s12, 36864
    s_nop 0
    buffer_load_dwordx4 v24, s[40:43], s14 offen lds
    s_add_u32 m0, s12, 37888
    s_nop 0
    buffer_load_dwordx4 v25, s[40:43], s14 offen lds
    s_add_u32 m0, s12, 38912
    s_nop 0
    buffer_load_dwordx4 v26, s[40:43], s14 offen lds
    buffer_load_dwordx4 v[64:67], v20, s[36:39], 0 offen offset:768
    buffer_load_dwordx4 v[68:71], v21, s[36:39], 0 offen offset:768
    buffer_load_dwordx4 v[72:75], v22, s[36:39], 0 offen offset:768
    buffer_load_dwordx4 v[76:79], v23, s[36:39], 0 offen offset:768
    v_cvt_f32_i32 v80, v80
    v_cvt_f32_i32 v81, v81
    v_cvt_f32_i32 v82, v82
    v_cvt_f32_i32 v83, v83
    v_cvt_f32_i32 v84, v84
    v_cvt_f32_i32 v85, v85
    v_cvt_f32_i32 v86, v86
    v_cvt_f32_i32 v87, v87
    v_cvt_f32_i32 v88, v88
    v_cvt_f32_i32 v89, v89
    v_cvt_f32_i32 v90, v90
    v_cvt_f32_i32 v91, v91
    v_cvt_f32_i32 v92, v92
    v_cvt_f32_i32 v93, v93
    v_cvt_f32_i32 v94, v94
    v_cvt_f32_i32 v95, v95
    s_waitcnt lgkmcnt(0)
    v_fma_f32 v80, v80, v36, v40
    v_fma_f32 v81, v81, v37, v41
    v_fma_f32 v82, v82, v38, v42
    v_fma_f32 v83, v83, v39, v43
    v_cvt_pk_bf16_f32 v44, v80, v81
    v_cvt_pk_bf16_f32 v45, v82, v83
    ds_write_b64 v28, v[44:45] offset:8192
    v_fma_f32 v84, v84, v36, v40
    v_fma_f32 v85, v85, v37, v41
    v_fma_f32 v86, v86, v38, v42
    v_fma_f32 v87, v87, v39, v43
    v_cvt_pk_bf16_f32 v46, v84, v85
    v_cvt_pk_bf16_f32 v47, v86, v87
    ds_write_b64 v29, v[46:47] offset:8192
    v_fma_f32 v88, v88, v36, v40
    v_fma_f32 v89, v89, v37, v41
    v_fma_f32 v90, v90, v38, v42
    v_fma_f32 v91, v91, v39, v43
    v_cvt_pk_bf16_f32 v48, v88, v89
    v_cvt_pk_bf16_f32 v49, v90, v91
    ds_write_b64 v30, v[48:49] offset:8192
    v_fma_f32 v92, v92, v36, v40
    v_fma_f32 v93, v93, v37, v41
    v_fma_f32 v94, v94, v38, v42
    v_fma_f32 v95, v95, v39, v43
    v_cvt_pk_bf16_f32 v50, v92, v93
    v_cvt_pk_bf16_f32 v51, v94, v95
    ds_write_b64 v31, v[50:51] offset:8192
    ds_read_b128 v[36:39], v27 offset:512
    ds_read_b128 v[40:43], v27 offset:8704
    s_waitcnt lgkmcnt(2)
    s_barrier
    s_waitcnt vmcnt(7)
    s_mov_b32 s14, 786432
    s_add_u32 m0, s12, 0
    s_nop 0
    buffer_load_dwordx4 v24, s[40:43], s14 offen lds
    s_add_u32 m0, s12, 1024
    s_nop 0
    buffer_load_dwordx4 v25, s[40:43], s14 offen lds
    s_add_u32 m0, s12, 2048
    s_nop 0
    buffer_load_dwordx4 v26, s[40:43], s14 offen lds
    buffer_load_dwordx4 v[80:83], v20, s[36:39], 0 offen offset:1024
    buffer_load_dwordx4 v[84:87], v21, s[36:39], 0 offen offset:1024
    buffer_load_dwordx4 v[88:91], v22, s[36:39], 0 offen offset:1024
    buffer_load_dwordx4 v[92:95], v23, s[36:39], 0 offen offset:1024
    v_cvt_f32_i32 v96, v96
    v_cvt_f32_i32 v97, v97
    v_cvt_f32_i32 v98, v98
    v_cvt_f32_i32 v99, v99
    v_cvt_f32_i32 v100, v100
    v_cvt_f32_i32 v101, v101
    v_cvt_f32_i32 v102, v102
    v_cvt_f32_i32 v103, v103
    v_cvt_f32_i32 v104, v104
    v_cvt_f32_i32 v105, v105
    v_cvt_f32_i32 v106, v106
    v_cvt_f32_i32 v107, v107
    v_cvt_f32_i32 v108, v108
    v_cvt_f32_i32 v109, v109
    v_cvt_f32_i32 v110, v110
    v_cvt_f32_i32 v111, v111
    s_waitcnt lgkmcnt(0)
    v_fma_f32 v96, v96, v36, v40
    v_fma_f32 v97, v97, v37, v41
    v_fma_f32 v98, v98, v38, v42
    v_fma_f32 v99, v99, v39, v43
    v_cvt_pk_bf16_f32 v44, v96, v97
    v_cvt_pk_bf16_f32 v45, v98, v99
    ds_write_b64 v28, v[44:45] offset:16384
    v_fma_f32 v100, v100, v36, v40
    v_fma_f32 v101, v101, v37, v41
    v_fma_f32 v102, v102, v38, v42
    v_fma_f32 v103, v103, v39, v43
    v_cvt_pk_bf16_f32 v46, v100, v101
    v_cvt_pk_bf16_f32 v47, v102, v103
    ds_write_b64 v29, v[46:47] offset:16384
    v_fma_f32 v104, v104, v36, v40
    v_fma_f32 v105, v105, v37, v41
    v_fma_f32 v106, v106, v38, v42
    v_fma_f32 v107, v107, v39, v43
    v_cvt_pk_bf16_f32 v48, v104, v105
    v_cvt_pk_bf16_f32 v49, v106, v107
    ds_write_b64 v30, v[48:49] offset:16384
    v_fma_f32 v108, v108, v36, v40
    v_fma_f32 v109, v109, v37, v41
    v_fma_f32 v110, v110, v38, v42
    v_fma_f32 v111, v111, v39, v43
    v_cvt_pk_bf16_f32 v50, v108, v109
    v_cvt_pk_bf16_f32 v51, v110, v111
    ds_write_b64 v31, v[50:51] offset:16384
    ds_read_b128 v[36:39], v27 offset:768
    ds_read_b128 v[40:43], v27 offset:8960
    s_waitcnt lgkmcnt(2)
    s_barrier
    s_waitcnt vmcnt(7)
    s_mov_b32 s14, 983040
    s_add_u32 m0, s12, 12288
    s_nop 0
    buffer_load_dwordx4 v24, s[40:43], s14 offen lds
    s_add_u32 m0, s12, 13312
    s_nop 0
    buffer_load_dwordx4 v25, s[40:43], s14 offen lds
    s_add_u32 m0, s12, 14336
    s_nop 0
    buffer_load_dwordx4 v26, s[40:43], s14 offen lds
    buffer_load_dwordx4 v[96:99], v20, s[36:39], 0 offen offset:1280
    buffer_load_dwordx4 v[100:103], v21, s[36:39], 0 offen offset:1280
    buffer_load_dwordx4 v[104:107], v22, s[36:39], 0 offen offset:1280
    buffer_load_dwordx4 v[108:111], v23, s[36:39], 0 offen offset:1280
    v_cvt_f32_i32 v64, v64
    v_cvt_f32_i32 v65, v65
    v_cvt_f32_i32 v66, v66
    v_cvt_f32_i32 v67, v67
    v_cvt_f32_i32 v68, v68
    v_cvt_f32_i32 v69, v69
    v_cvt_f32_i32 v70, v70
    v_cvt_f32_i32 v71, v71
    v_cvt_f32_i32 v72, v72
    v_cvt_f32_i32 v73, v73
    v_cvt_f32_i32 v74, v74
    v_cvt_f32_i32 v75, v75
    v_cvt_f32_i32 v76, v76
    v_cvt_f32_i32 v77, v77
    v_cvt_f32_i32 v78, v78
    v_cvt_f32_i32 v79, v79
    s_waitcnt lgkmcnt(0)
    v_fma_f32 v64, v64, v36, v40
    v_fma_f32 v65, v65, v37, v41
    v_fma_f32 v66, v66, v38, v42
    v_fma_f32 v67, v67, v39, v43
    v_cvt_pk_bf16_f32 v44, v64, v65
    v_cvt_pk_bf16_f32 v45, v66, v67
    ds_write_b64 v28, v[44:45] offset:24576
    v_fma_f32 v68, v68, v36, v40
    v_fma_f32 v69, v69, v37, v41
    v_fma_f32 v70, v70, v38, v42
    v_fma_f32 v71, v71, v39, v43
    v_cvt_pk_bf16_f32 v46, v68, v69
    v_cvt_pk_bf16_f32 v47, v70, v71
    ds_write_b64 v29, v[46:47] offset:24576
    v_fma_f32 v72, v72, v36, v40
    v_fma_f32 v73, v73, v37, v41
    v_fma_f32 v74, v74, v38, v42
    v_fma_f32 v75, v75, v39, v43
    v_cvt_pk_bf16_f32 v48, v72, v73
    v_cvt_pk_bf16_f32 v49, v74, v75
    ds_write_b64 v30, v[48:49] offset:24576
    v_fma_f32 v76, v76, v36, v40
    v_fma_f32 v77, v77, v37, v41
    v_fma_f32 v78, v78, v38, v42
    v_fma_f32 v79, v79, v39, v43
    v_cvt_pk_bf16_f32 v50, v76, v77
    v_cvt_pk_bf16_f32 v51, v78, v79
    ds_write_b64 v31, v[50:51] offset:24576
    ds_read_b128 v[36:39], v27 offset:1024
    ds_read_b128 v[40:43], v27 offset:9216
    s_waitcnt lgkmcnt(2)
    s_barrier
    s_waitcnt vmcnt(7)
    s_mov_b32 s14, 1179648
    s_add_u32 m0, s12, 24576
    s_nop 0
    buffer_load_dwordx4 v24, s[40:43], s14 offen lds
    s_add_u32 m0, s12, 25600
    s_nop 0
    buffer_load_dwordx4 v25, s[40:43], s14 offen lds
    s_add_u32 m0, s12, 26624
    s_nop 0
    buffer_load_dwordx4 v26, s[40:43], s14 offen lds
    buffer_load_dwordx4 v[64:67], v20, s[36:39], 0 offen offset:1536
    buffer_load_dwordx4 v[68:71], v21, s[36:39], 0 offen offset:1536
    buffer_load_dwordx4 v[72:75], v22, s[36:39], 0 offen offset:1536
    buffer_load_dwordx4 v[76:79], v23, s[36:39], 0 offen offset:1536
    v_cvt_f32_i32 v80, v80
    v_cvt_f32_i32 v81, v81
    v_cvt_f32_i32 v82, v82
    v_cvt_f32_i32 v83, v83
    v_cvt_f32_i32 v84, v84
    v_cvt_f32_i32 v85, v85
    v_cvt_f32_i32 v86, v86
    v_cvt_f32_i32 v87, v87
    v_cvt_f32_i32 v88, v88
    v_cvt_f32_i32 v89, v89
    v_cvt_f32_i32 v90, v90
    v_cvt_f32_i32 v91, v91
    v_cvt_f32_i32 v92, v92
    v_cvt_f32_i32 v93, v93
    v_cvt_f32_i32 v94, v94
    v_cvt_f32_i32 v95, v95
    s_waitcnt lgkmcnt(0)
    v_fma_f32 v80, v80, v36, v40
    v_fma_f32 v81, v81, v37, v41
    v_fma_f32 v82, v82, v38, v42
    v_fma_f32 v83, v83, v39, v43
    v_cvt_pk_bf16_f32 v44, v80, v81
    v_cvt_pk_bf16_f32 v45, v82, v83
    ds_write_b64 v28, v[44:45] offset:0
    v_fma_f32 v84, v84, v36, v40
    v_fma_f32 v85, v85, v37, v41
    v_fma_f32 v86, v86, v38, v42
    v_fma_f32 v87, v87, v39, v43
    v_cvt_pk_bf16_f32 v46, v84, v85
    v_cvt_pk_bf16_f32 v47, v86, v87
    ds_write_b64 v29, v[46:47] offset:0
    v_fma_f32 v88, v88, v36, v40
    v_fma_f32 v89, v89, v37, v41
    v_fma_f32 v90, v90, v38, v42
    v_fma_f32 v91, v91, v39, v43
    v_cvt_pk_bf16_f32 v48, v88, v89
    v_cvt_pk_bf16_f32 v49, v90, v91
    ds_write_b64 v30, v[48:49] offset:0
    v_fma_f32 v92, v92, v36, v40
    v_fma_f32 v93, v93, v37, v41
    v_fma_f32 v94, v94, v38, v42
    v_fma_f32 v95, v95, v39, v43
    v_cvt_pk_bf16_f32 v50, v92, v93
    v_cvt_pk_bf16_f32 v51, v94, v95
    ds_write_b64 v31, v[50:51] offset:0
    ds_read_b128 v[36:39], v27 offset:1280
    ds_read_b128 v[40:43], v27 offset:9472
    s_waitcnt lgkmcnt(2)
    s_barrier
    s_waitcnt vmcnt(7)
    s_mov_b32 s14, 1376256
    s_add_u32 m0, s12, 36864
    s_nop 0
    buffer_load_dwordx4 v24, s[40:43], s14 offen lds
    s_add_u32 m0, s12, 37888
    s_nop 0
    buffer_load_dwordx4 v25, s[40:43], s14 offen lds
    s_add_u32 m0, s12, 38912
    s_nop 0
    buffer_load_dwordx4 v26, s[40:43], s14 offen lds
    buffer_load_dwordx4 v[80:83], v20, s[36:39], 0 offen offset:1792
    buffer_load_dwordx4 v[84:87], v21, s[36:39], 0 offen offset:1792
    buffer_load_dwordx4 v[88:91], v22, s[36:39], 0 offen offset:1792
    buffer_load_dwordx4 v[92:95], v23, s[36:39], 0 offen offset:1792
    v_cvt_f32_i32 v96, v96
    v_cvt_f32_i32 v97, v97
    v_cvt_f32_i32 v98, v98
    v_cvt_f32_i32 v99, v99
    v_cvt_f32_i32 v100, v100
    v_cvt_f32_i32 v101, v101
    v_cvt_f32_i32 v102, v102
    v_cvt_f32_i32 v103, v103
    v_cvt_f32_i32 v104, v104
    v_cvt_f32_i32 v105, v105
    v_cvt_f32_i32 v106, v106
    v_cvt_f32_i32 v107, v107
    v_cvt_f32_i32 v108, v108
    v_cvt_f32_i32 v109, v109
    v_cvt_f32_i32 v110, v110
    v_cvt_f32_i32 v111, v111
    s_waitcnt lgkmcnt(0)
    v_fma_f32 v96, v96, v36, v40
    v_fma_f32 v97, v97, v37, v41
    v_fma_f32 v98, v98, v38, v42
    v_fma_f32 v99, v99, v39, v43
    v_cvt_pk_bf16_f32 v44, v96, v97
    v_cvt_pk_bf16_f32 v45, v98, v99
    ds_write_b64 v28, v[44:45] offset:8192
    v_fma_f32 v100, v100, v36, v40
    v_fma_f32 v101, v101, v37, v41
    v_fma_f32 v102, v102, v38, v42
    v_fma_f32 v103, v103, v39, v43
    v_cvt_pk_bf16_f32 v46, v100, v101
    v_cvt_pk_bf16_f32 v47, v102, v103
    ds_write_b64 v29, v[46:47] offset:8192
    v_fma_f32 v104, v104, v36, v40
    v_fma_f32 v105, v105, v37, v41
    v_fma_f32 v106, v106, v38, v42
    v_fma_f32 v107, v107, v39, v43
    v_cvt_pk_bf16_f32 v48, v104, v105
    v_cvt_pk_bf16_f32 v49, v106, v107
    ds_write_b64 v30, v[48:49] offset:8192
    v_fma_f32 v108, v108, v36, v40
    v_fma_f32 v109, v109, v37, v41
    v_fma_f32 v110, v110, v38, v42
    v_fma_f32 v111, v111, v39, v43
    v_cvt_pk_bf16_f32 v50, v108, v109
    v_cvt_pk_bf16_f32 v51, v110, v111
    ds_write_b64 v31, v[50:51] offset:8192
    ds_read_b128 v[36:39], v27 offset:1536
    ds_read_b128 v[40:43], v27 offset:9728
    s_waitcnt lgkmcnt(2)
    s_barrier
    s_waitcnt vmcnt(7)
    s_mov_b32 s14, 1572864
    s_add_u32 m0, s12, 0
    s_nop 0
    buffer_load_dwordx4 v24, s[40:43], s14 offen lds
    s_add_u32 m0, s12, 1024
    s_nop 0
    buffer_load_dwordx4 v25, s[40:43], s14 offen lds
    s_add_u32 m0, s12, 2048
    s_nop 0
    buffer_load_dwordx4 v26, s[40:43], s14 offen lds
    buffer_load_dwordx4 v[96:99], v20, s[36:39], 0 offen offset:2048
    buffer_load_dwordx4 v[100:103], v21, s[36:39], 0 offen offset:2048
    buffer_load_dwordx4 v[104:107], v22, s[36:39], 0 offen offset:2048
    buffer_load_dwordx4 v[108:111], v23, s[36:39], 0 offen offset:2048
    v_cvt_f32_i32 v64, v64
    v_cvt_f32_i32 v65, v65
    v_cvt_f32_i32 v66, v66
    v_cvt_f32_i32 v67, v67
    v_cvt_f32_i32 v68, v68
    v_cvt_f32_i32 v69, v69
    v_cvt_f32_i32 v70, v70
    v_cvt_f32_i32 v71, v71
    v_cvt_f32_i32 v72, v72
    v_cvt_f32_i32 v73, v73
    v_cvt_f32_i32 v74, v74
    v_cvt_f32_i32 v75, v75
    v_cvt_f32_i32 v76, v76
    v_cvt_f32_i32 v77, v77
    v_cvt_f32_i32 v78, v78
    v_cvt_f32_i32 v79, v79
    s_waitcnt lgkmcnt(0)
    v_fma_f32 v64, v64, v36, v40
    v_fma_f32 v65, v65, v37, v41
    v_fma_f32 v66, v66, v38, v42
    v_fma_f32 v67, v67, v39, v43
    v_cvt_pk_bf16_f32 v44, v64, v65
    v_cvt_pk_bf16_f32 v45, v66, v67
    ds_write_b64 v28, v[44:45] offset:16384
    v_fma_f32 v68, v68, v36, v40
    v_fma_f32 v69, v69, v37, v41
    v_fma_f32 v70, v70, v38, v42
    v_fma_f32 v71, v71, v39, v43
    v_cvt_pk_bf16_f32 v46, v68, v69
    v_cvt_pk_bf16_f32 v47, v70, v71
    ds_write_b64 v29, v[46:47] offset:16384
    v_fma_f32 v72, v72, v36, v40
    v_fma_f32 v73, v73, v37, v41
    v_fma_f32 v74, v74, v38, v42
    v_fma_f32 v75, v75, v39, v43
    v_cvt_pk_bf16_f32 v48, v72, v73
    v_cvt_pk_bf16_f32 v49, v74, v75
    ds_write_b64 v30, v[48:49] offset:16384
    v_fma_f32 v76, v76, v36, v40
    v_fma_f32 v77, v77, v37, v41
    v_fma_f32 v78, v78, v38, v42
    v_fma_f32 v79, v79, v39, v43
    v_cvt_pk_bf16_f32 v50, v76, v77
    v_cvt_pk_bf16_f32 v51, v78, v79
    ds_write_b64 v31, v[50:51] offset:16384
    ds_read_b128 v[36:39], v27 offset:1792
    ds_read_b128 v[40:43], v27 offset:9984
    s_waitcnt lgkmcnt(2)
    s_barrier
    s_waitcnt vmcnt(7)
    s_mov_b32 s14, 1769472
    s_add_u32 m0, s12, 12288
    s_nop 0
    buffer_load_dwordx4 v24, s[40:43], s14 offen lds
    s_add_u32 m0, s12, 13312
    s_nop 0
    buffer_load_dwordx4 v25, s[40:43], s14 offen lds
    s_add_u32 m0, s12, 14336
    s_nop 0
    buffer_load_dwordx4 v26, s[40:43], s14 offen lds
    buffer_load_dwordx4 v[64:67], v20, s[36:39], 0 offen offset:2304
    buffer_load_dwordx4 v[68:71], v21, s[36:39], 0 offen offset:2304
    buffer_load_dwordx4 v[72:75], v22, s[36:39], 0 offen offset:2304
    buffer_load_dwordx4 v[76:79], v23, s[36:39], 0 offen offset:2304
    v_cvt_f32_i32 v80, v80
    v_cvt_f32_i32 v81, v81
    v_cvt_f32_i32 v82, v82
    v_cvt_f32_i32 v83, v83
    v_cvt_f32_i32 v84, v84
    v_cvt_f32_i32 v85, v85
    v_cvt_f32_i32 v86, v86
    v_cvt_f32_i32 v87, v87
    v_cvt_f32_i32 v88, v88
    v_cvt_f32_i32 v89, v89
    v_cvt_f32_i32 v90, v90
    v_cvt_f32_i32 v91, v91
    v_cvt_f32_i32 v92, v92
    v_cvt_f32_i32 v93, v93
    v_cvt_f32_i32 v94, v94
    v_cvt_f32_i32 v95, v95
    s_waitcnt lgkmcnt(0)
    v_fma_f32 v80, v80, v36, v40
    v_fma_f32 v81, v81, v37, v41
    v_fma_f32 v82, v82, v38, v42
    v_fma_f32 v83, v83, v39, v43
    v_cvt_pk_bf16_f32 v44, v80, v81
    v_cvt_pk_bf16_f32 v45, v82, v83
    ds_write_b64 v28, v[44:45] offset:24576
    v_fma_f32 v84, v84, v36, v40
    v_fma_f32 v85, v85, v37, v41
    v_fma_f32 v86, v86, v38, v42
    v_fma_f32 v87, v87, v39, v43
    v_cvt_pk_bf16_f32 v46, v84, v85
    v_cvt_pk_bf16_f32 v47, v86, v87
    ds_write_b64 v29, v[46:47] offset:24576
    v_fma_f32 v88, v88, v36, v40
    v_fma_f32 v89, v89, v37, v41
    v_fma_f32 v90, v90, v38, v42
    v_fma_f32 v91, v91, v39, v43
    v_cvt_pk_bf16_f32 v48, v88, v89
    v_cvt_pk_bf16_f32 v49, v90, v91
    ds_write_b64 v30, v[48:49] offset:24576
    v_fma_f32 v92, v92, v36, v40
    v_fma_f32 v93, v93, v37, v41
    v_fma_f32 v94, v94, v38, v42
    v_fma_f32 v95, v95, v39, v43
    v_cvt_pk_bf16_f32 v50, v92, v93
    v_cvt_pk_bf16_f32 v51, v94, v95
    ds_write_b64 v31, v[50:51] offset:24576
    ds_read_b128 v[36:39], v27 offset:2048
    ds_read_b128 v[40:43], v27 offset:10240
    s_waitcnt lgkmcnt(2)
    s_barrier
    s_waitcnt vmcnt(7)
    s_mov_b32 s14, 1966080
    s_add_u32 m0, s12, 24576
    s_nop 0
    buffer_load_dwordx4 v24, s[40:43], s14 offen lds
    s_add_u32 m0, s12, 25600
    s_nop 0
    buffer_load_dwordx4 v25, s[40:43], s14 offen lds
    s_add_u32 m0, s12, 26624
    s_nop 0
    buffer_load_dwordx4 v26, s[40:43], s14 offen lds
    s_add_u32 s13, s15, 81920
    s_add_u32 m0, s34, 16384
    s_nop 0
    buffer_load_dwordx4 v33, s[48:51], s13 offen sc1 lds
    buffer_load_dwordx4 v33, s[48:51], s13 offen offset:1024 sc1 lds
    v_cvt_f32_i32 v96, v96
    v_cvt_f32_i32 v97, v97
    v_cvt_f32_i32 v98, v98
    v_cvt_f32_i32 v99, v99
    v_cvt_f32_i32 v100, v100
    v_cvt_f32_i32 v101, v101
    v_cvt_f32_i32 v102, v102
    v_cvt_f32_i32 v103, v103
    v_cvt_f32_i32 v104, v104
    v_cvt_f32_i32 v105, v105
    v_cvt_f32_i32 v106, v106
    v_cvt_f32_i32 v107, v107
    v_cvt_f32_i32 v108, v108
    v_cvt_f32_i32 v109, v109
    v_cvt_f32_i32 v110, v110
    v_cvt_f32_i32 v111, v111
    s_waitcnt lgkmcnt(0)
    v_fma_f32 v96, v96, v36, v40
    v_fma_f32 v97, v97, v37, v41
    v_fma_f32 v98, v98, v38, v42
    v_fma_f32 v99, v99, v39, v43
    v_cvt_pk_bf16_f32 v44, v96, v97
    v_cvt_pk_bf16_f32 v45, v98, v99
    ds_write_b64 v28, v[44:45] offset:0
    v_fma_f32 v100, v100, v36, v40
    v_fma_f32 v101, v101, v37, v41
    v_fma_f32 v102, v102, v38, v42
    v_fma_f32 v103, v103, v39, v43
    v_cvt_pk_bf16_f32 v46, v100, v101
    v_cvt_pk_bf16_f32 v47, v102, v103
    ds_write_b64 v29, v[46:47] offset:0
    v_fma_f32 v104, v104, v36, v40
    v_fma_f32 v105, v105, v37, v41
    v_fma_f32 v106, v106, v38, v42
    v_fma_f32 v107, v107, v39, v43
    v_cvt_pk_bf16_f32 v48, v104, v105
    v_cvt_pk_bf16_f32 v49, v106, v107
    ds_write_b64 v30, v[48:49] offset:0
    v_fma_f32 v108, v108, v36, v40
    v_fma_f32 v109, v109, v37, v41
    v_fma_f32 v110, v110, v38, v42
    v_fma_f32 v111, v111, v39, v43
    v_cvt_pk_bf16_f32 v50, v108, v109
    v_cvt_pk_bf16_f32 v51, v110, v111
    ds_write_b64 v31, v[50:51] offset:0
    ds_read_b128 v[36:39], v27 offset:2304
    ds_read_b128 v[40:43], v27 offset:10496
    s_waitcnt lgkmcnt(2)
    s_barrier
    s_waitcnt vmcnt(5)
    s_mov_b32 s14, 2162688
    s_add_u32 m0, s12, 36864
    s_nop 0
    buffer_load_dwordx4 v24, s[40:43], s14 offen lds
    s_add_u32 m0, s12, 37888
    s_nop 0
    buffer_load_dwordx4 v25, s[40:43], s14 offen lds
    s_add_u32 m0, s12, 38912
    s_nop 0
    buffer_load_dwordx4 v26, s[40:43], s14 offen lds
    s_add_u32 s13, s15, 90112
    s_add_u32 m0, s34, 24576
    s_nop 0
    buffer_load_dwordx4 v33, s[48:51], s13 offen sc1 lds
    buffer_load_dwordx4 v33, s[48:51], s13 offen offset:1024 sc1 lds
    v_cvt_f32_i32 v64, v64
    v_cvt_f32_i32 v65, v65
    v_cvt_f32_i32 v66, v66
    v_cvt_f32_i32 v67, v67
    v_cvt_f32_i32 v68, v68
    v_cvt_f32_i32 v69, v69
    v_cvt_f32_i32 v70, v70
    v_cvt_f32_i32 v71, v71
    v_cvt_f32_i32 v72, v72
    v_cvt_f32_i32 v73, v73
    v_cvt_f32_i32 v74, v74
    v_cvt_f32_i32 v75, v75
    v_cvt_f32_i32 v76, v76
    v_cvt_f32_i32 v77, v77
    v_cvt_f32_i32 v78, v78
    v_cvt_f32_i32 v79, v79
    s_waitcnt lgkmcnt(0)
    v_fma_f32 v64, v64, v36, v40
    v_fma_f32 v65, v65, v37, v41
    v_fma_f32 v66, v66, v38, v42
    v_fma_f32 v67, v67, v39, v43
    v_cvt_pk_bf16_f32 v44, v64, v65
    v_cvt_pk_bf16_f32 v45, v66, v67
    ds_write_b64 v28, v[44:45] offset:8192
    v_fma_f32 v68, v68, v36, v40
    v_fma_f32 v69, v69, v37, v41
    v_fma_f32 v70, v70, v38, v42
    v_fma_f32 v71, v71, v39, v43
    v_cvt_pk_bf16_f32 v46, v68, v69
    v_cvt_pk_bf16_f32 v47, v70, v71
    ds_write_b64 v29, v[46:47] offset:8192
    v_fma_f32 v72, v72, v36, v40
    v_fma_f32 v73, v73, v37, v41
    v_fma_f32 v74, v74, v38, v42
    v_fma_f32 v75, v75, v39, v43
    v_cvt_pk_bf16_f32 v48, v72, v73
    v_cvt_pk_bf16_f32 v49, v74, v75
    ds_write_b64 v30, v[48:49] offset:8192
    v_fma_f32 v76, v76, v36, v40
    v_fma_f32 v77, v77, v37, v41
    v_fma_f32 v78, v78, v38, v42
    v_fma_f32 v79, v79, v39, v43
    v_cvt_pk_bf16_f32 v50, v76, v77
    v_cvt_pk_bf16_f32 v51, v78, v79
    ds_write_b64 v31, v[50:51] offset:8192
    s_waitcnt lgkmcnt(0)
    s_barrier
    s_waitcnt vmcnt(5)
    s_mov_b32 s14, 2359296
    s_add_u32 m0, s12, 0
    s_nop 0
    buffer_load_dwordx4 v24, s[40:43], s14 offen lds
    s_add_u32 m0, s12, 1024
    s_nop 0
    buffer_load_dwordx4 v25, s[40:43], s14 offen lds
    s_add_u32 m0, s12, 2048
    s_nop 0
    buffer_load_dwordx4 v26, s[40:43], s14 offen lds
    s_add_u32 s13, s15, 98304
    s_add_u32 m0, s34, 0
    s_nop 0
    buffer_load_dwordx4 v33, s[48:51], s13 offen sc1 lds
    buffer_load_dwordx4 v33, s[48:51], s13 offen offset:1024 sc1 lds
    s_barrier
    s_waitcnt vmcnt(5)
    s_mov_b32 s14, 2555904
    s_add_u32 m0, s12, 12288
    s_nop 0
    buffer_load_dwordx4 v24, s[40:43], s14 offen lds
    s_add_u32 m0, s12, 13312
    s_nop 0
    buffer_load_dwordx4 v25, s[40:43], s14 offen lds
    s_add_u32 m0, s12, 14336
    s_nop 0
    buffer_load_dwordx4 v26, s[40:43], s14 offen lds
    s_add_u32 s13, s15, 106496
    s_add_u32 m0, s34, 8192
    s_nop 0
    buffer_load_dwordx4 v33, s[48:51], s13 offen sc1 lds
    buffer_load_dwordx4 v33, s[48:51], s13 offen offset:1024 sc1 lds
    s_barrier
    s_waitcnt vmcnt(5)
    s_mov_b32 s14, 2752512
    s_add_u32 m0, s12, 24576
    s_nop 0
    buffer_load_dwordx4 v24, s[40:43], s14 offen lds
    s_add_u32 m0, s12, 25600
    s_nop 0
    buffer_load_dwordx4 v25, s[40:43], s14 offen lds
    s_add_u32 m0, s12, 26624
    s_nop 0
    buffer_load_dwordx4 v26, s[40:43], s14 offen lds
    s_add_u32 s13, s15, 114688
    s_add_u32 m0, s34, 16384
    s_nop 0
    buffer_load_dwordx4 v33, s[48:51], s13 offen sc1 lds
    buffer_load_dwordx4 v33, s[48:51], s13 offen offset:1024 sc1 lds
    s_barrier
    s_waitcnt vmcnt(5)
    s_mov_b32 s14, 2949120
    s_add_u32 m0, s12, 36864
    s_nop 0
    buffer_load_dwordx4 v24, s[40:43], s14 offen lds
    s_add_u32 m0, s12, 37888
    s_nop 0
    buffer_load_dwordx4 v25, s[40:43], s14 offen lds
    s_add_u32 m0, s12, 38912
    s_nop 0
    buffer_load_dwordx4 v26, s[40:43], s14 offen lds
    s_add_u32 s13, s15, 122880
    s_add_u32 m0, s34, 24576
    s_nop 0
    buffer_load_dwordx4 v33, s[48:51], s13 offen sc1 lds
    buffer_load_dwordx4 v33, s[48:51], s13 offen offset:1024 sc1 lds
    s_barrier
    s_waitcnt vmcnt(5)
    s_mov_b32 s14, 3145728
    s_add_u32 m0, s12, 0
    s_nop 0
    buffer_load_dwordx4 v24, s[40:43], s14 offen lds
    s_add_u32 m0, s12, 1024
    s_nop 0
    buffer_load_dwordx4 v25, s[40:43], s14 offen lds
    s_add_u32 m0, s12, 2048
    s_nop 0
    buffer_load_dwordx4 v26, s[40:43], s14 offen lds
    s_add_u32 s13, s15, 131072
    s_add_u32 m0, s34, 0
    s_nop 0
    buffer_load_dwordx4 v33, s[48:51], s13 offen sc1 lds
    buffer_load_dwordx4 v33, s[48:51], s13 offen offset:1024 sc1 lds
    s_barrier
    s_waitcnt vmcnt(5)
    s_mov_b32 s14, 3342336
    s_add_u32 m0, s12, 12288
    s_nop 0
    buffer_load_dwordx4 v24, s[40:43], s14 offen lds
    s_add_u32 m0, s12, 13312
    s_nop 0
    buffer_load_dwordx4 v25, s[40:43], s14 offen lds
    s_add_u32 m0, s12, 14336
    s_nop 0
    buffer_load_dwordx4 v26, s[40:43], s14 offen lds
    s_add_u32 s13, s15, 139264
    s_add_u32 m0, s34, 8192
    s_nop 0
    buffer_load_dwordx4 v33, s[48:51], s13 offen sc1 lds
    buffer_load_dwordx4 v33, s[48:51], s13 offen offset:1024 sc1 lds
    s_barrier
    s_waitcnt vmcnt(5)
    s_mov_b32 s14, 3538944
    s_add_u32 m0, s12, 24576
    s_nop 0
    buffer_load_dwordx4 v24, s[40:43], s14 offen lds
    s_add_u32 m0, s12, 25600
    s_nop 0
    buffer_load_dwordx4 v25, s[40:43], s14 offen lds
    s_add_u32 m0, s12, 26624
    s_nop 0
    buffer_load_dwordx4 v26, s[40:43], s14 offen lds
    s_add_u32 s13, s15, 147456
    s_add_u32 m0, s34, 16384
    s_nop 0
    buffer_load_dwordx4 v33, s[48:51], s13 offen sc1 lds
    buffer_load_dwordx4 v33, s[48:51], s13 offen offset:1024 sc1 lds
    s_barrier
    s_waitcnt vmcnt(5)
    s_mov_b32 s14, 3735552
    s_add_u32 m0, s12, 36864
    s_nop 0
    buffer_load_dwordx4 v24, s[40:43], s14 offen lds
    s_add_u32 m0, s12, 37888
    s_nop 0
    buffer_load_dwordx4 v25, s[40:43], s14 offen lds
    s_add_u32 m0, s12, 38912
    s_nop 0
    buffer_load_dwordx4 v26, s[40:43], s14 offen lds
    s_add_u32 s13, s15, 155648
    s_add_u32 m0, s34, 24576
    s_nop 0
    buffer_load_dwordx4 v33, s[48:51], s13 offen sc1 lds
    buffer_load_dwordx4 v33, s[48:51], s13 offen offset:1024 sc1 lds
    s_barrier
    s_waitcnt vmcnt(5)
    s_mov_b32 s14, 3932160
    s_add_u32 m0, s12, 0
    s_nop 0
    buffer_load_dwordx4 v24, s[40:43], s14 offen lds
    s_add_u32 m0, s12, 1024
    s_nop 0
    buffer_load_dwordx4 v25, s[40:43], s14 offen lds
    s_add_u32 m0, s12, 2048
    s_nop 0
    buffer_load_dwordx4 v26, s[40:43], s14 offen lds
    s_add_u32 s13, s15, 163840
    s_add_u32 m0, s34, 0
    s_nop 0
    buffer_load_dwordx4 v33, s[48:51], s13 offen sc1 lds
    buffer_load_dwordx4 v33, s[48:51], s13 offen offset:1024 sc1 lds
    s_barrier
    s_waitcnt vmcnt(5)
    s_mov_b32 s14, 4128768
    s_add_u32 m0, s12, 12288
    s_nop 0
    buffer_load_dwordx4 v24, s[40:43], s14 offen lds
    s_add_u32 m0, s12, 13312
    s_nop 0
    buffer_load_dwordx4 v25, s[40:43], s14 offen lds
    s_add_u32 m0, s12, 14336
    s_nop 0
    buffer_load_dwordx4 v26, s[40:43], s14 offen lds
    s_add_u32 s13, s15, 172032
    s_add_u32 m0, s34, 8192
    s_nop 0
    buffer_load_dwordx4 v33, s[48:51], s13 offen sc1 lds
    buffer_load_dwordx4 v33, s[48:51], s13 offen offset:1024 sc1 lds
    s_barrier
    s_waitcnt vmcnt(5)
    s_mov_b32 s14, 4325376
    s_add_u32 m0, s12, 24576
    s_nop 0
    buffer_load_dwordx4 v24, s[40:43], s14 offen lds
    s_add_u32 m0, s12, 25600
    s_nop 0
    buffer_load_dwordx4 v25, s[40:43], s14 offen lds
    s_add_u32 m0, s12, 26624
    s_nop 0
    buffer_load_dwordx4 v26, s[40:43], s14 offen lds
    s_add_u32 s13, s15, 180224
    s_add_u32 m0, s34, 16384
    s_nop 0
    buffer_load_dwordx4 v33, s[48:51], s13 offen sc1 lds
    buffer_load_dwordx4 v33, s[48:51], s13 offen offset:1024 sc1 lds
    s_barrier
    s_waitcnt vmcnt(5)
    s_mov_b32 s14, 4521984
    s_add_u32 m0, s12, 36864
    s_nop 0
    buffer_load_dwordx4 v24, s[40:43], s14 offen lds
    s_add_u32 m0, s12, 37888
    s_nop 0
    buffer_load_dwordx4 v25, s[40:43], s14 offen lds
    s_add_u32 m0, s12, 38912
    s_nop 0
    buffer_load_dwordx4 v26, s[40:43], s14 offen lds
    s_add_u32 s13, s15, 188416
    s_add_u32 m0, s34, 24576
    s_nop 0
    buffer_load_dwordx4 v33, s[48:51], s13 offen sc1 lds
    buffer_load_dwordx4 v33, s[48:51], s13 offen offset:1024 sc1 lds
    s_barrier
    s_waitcnt vmcnt(5)
    s_barrier
    s_waitcnt vmcnt(0)
    s_barrier
    s_barrier
    s_branch L2_load
L1a_cons:
    s_and_b32 s11, s4, 1
    s_lshr_b32 s12, s4, 1
    s_lshl_b32 s10, s4, 9
    v_lshlrev_b32 v1, 3, v0
    v_add_u32 v1, s10, v1
    v_and_b32 v16, 15, v0
    v_lshrrev_b32 v17, 4, v0
    v_lshrrev_b32 v18, 1, v16
    v_xor_b32 v18, v17, v18
    v_xor_b32 v19, 4, v18
    v_lshlrev_b32 v18, 4, v18
    v_lshlrev_b32 v19, 4, v19
    s_lshl_b32 s13, s11, 12
    s_add_u32 s13, s13, 16384
    v_lshl_add_u32 v20, v16, 7, s13
    v_add_u32 v18, v18, v20
    v_add_u32 v19, v19, v20
    s_waitcnt lgkmcnt(0)
    v_mov_b32 v10, 0
    v_mov_b32 v11, 131072
    ds_write_b32 v11, v10
    s_mov_b32 s48, s20
    s_and_b32 s49, s21, 0xffff
    s_mov_b32 s50, 3072
    s_mov_b32 s51, 0x00020000
    s_mov_b32 s52, s22
    s_and_b32 s53, s23, 0xffff
    s_mov_b32 s54, 3072
    s_mov_b32 s55, 0x00020000
    buffer_load_dwordx2 v[2:3], v1, s[48:51], 0 offen
    buffer_load_dwordx2 v[4:5], v1, s[52:55], 0 offen
    buffer_load_dwordx2 v[6:7], v1, s[48:51], 0 offen offset:2048
    buffer_load_dwordx2 v[8:9], v1, s[52:55], 0 offen offset:2048
    s_add_u32 s44, s32, 3145728
    s_addc_u32 s45, s33, 0
    s_and_b32 s45, s45, 0xffff
    s_mov_b32 s46, 1966080
    s_mov_b32 s47, 0x00020000
    v_lshlrev_b32 v1, 1, v1
    v_lshrrev_b32 v20, 2, v16
    v_and_b32 v21, 3, v16
    v_lshl_add_u32 v20, v17, 3, v20
    v_mul_u32_u24 v20, 192, v20
    v_and_b32 v22, 1, v17
    v_lshl_add_u32 v20, v22, 5, v20
    v_lshl_add_u32 v20, v21, 3, v20
    s_mul_i32 s13, s12, 96
    v_add_u32 v20, s13, v20
    s_mul_i32 s13, s12, 192
    v_mul_u32_u24 v22, s13, v22
    v_sub_u32 v21, v20, v22
    v_mov_b32 v24, 0
    v_mov_b32 v25, 0
    v_mov_b32 v26, 0
    v_mov_b32 v27, 0
    v_mov_b32 v28, 0
    v_mov_b32 v29, 0
    v_mov_b32 v30, 0
    v_mov_b32 v31, 0
    v_mov_b32 v32, 0
    v_mov_b32 v33, 0
    v_mov_b32 v34, 0
    v_mov_b32 v35, 0
    v_mov_b32 v36, 0
    v_mov_b32 v37, 0
    v_mov_b32 v38, 0
    v_mov_b32 v39, 0
    v_mov_b32 v40, 0
    v_mov_b32 v41, 0
    v_mov_b32 v42, 0
    v_mov_b32 v43, 0
    v_mov_b32 v44, 0
    v_mov_b32 v45, 0
    v_mov_b32 v46, 0
    v_mov_b32 v47, 0
    v_mov_b32 v88, 0
    v_mov_b32 v89, 0
    v_mov_b32 v90, 0
    v_mov_b32 v91, 0
    v_mov_b32 v92, 0
    v_mov_b32 v93, 0
    v_mov_b32 v94, 0
    v_mov_b32 v95, 0
    v_mov_b32 v96, 0
    v_mov_b32 v97, 0
    v_mov_b32 v98, 0
    v_mov_b32 v99, 0
    v_mov_b32 v100, 0
    v_mov_b32 v101, 0
    v_mov_b32 v102, 0
    v_mov_b32 v103, 0
    v_mov_b32 v104, 0
    v_mov_b32 v105, 0
    v_mov_b32 v106, 0
    v_mov_b32 v107, 0
    v_mov_b32 v108, 0
    v_mov_b32 v109, 0
    v_mov_b32 v110, 0
    v_mov_b32 v111, 0
    v_mov_b32 v112, 0
    v_mov_b32 v113, 0
    v_mov_b32 v114, 0
    v_mov_b32 v115, 0
    v_mov_b32 v116, 0
    v_mov_b32 v117, 0
    v_mov_b32 v118, 0
    v_mov_b32 v119, 0
    v_mov_b32 v120, 0
    v_mov_b32 v121, 0
    v_mov_b32 v122, 0
    v_mov_b32 v123, 0
    v_mov_b32 v124, 0
    v_mov_b32 v125, 0
    v_mov_b32 v126, 0
    v_mov_b32 v127, 0
    s_waitcnt vmcnt(2)
    v_lshlrev_b32 v128, 16, v2
    v_and_b32 v129, 0xffff0000, v2
    v_lshlrev_b32 v130, 16, v3
    v_and_b32 v131, 0xffff0000, v3
    v_lshlrev_b32 v132, 16, v4
    v_and_b32 v133, 0xffff0000, v4
    v_lshlrev_b32 v134, 16, v5
    v_and_b32 v135, 0xffff0000, v5
    v_mul_f32 v132, -v132, v128
    v_mul_f32 v133, -v133, v129
    v_mul_f32 v134, -v134, v130
    v_mul_f32 v135, -v135, v131
    ds_write_b128 v1, v[128:131] offset:0
    ds_write_b128 v1, v[132:135] offset:8192
    s_nop 1
    s_waitcnt vmcnt(0)
    v_lshlrev_b32 v128, 16, v6
    v_and_b32 v129, 0xffff0000, v6
    v_lshlrev_b32 v130, 16, v7
    v_and_b32 v131, 0xffff0000, v7
    v_lshlrev_b32 v132, 16, v8
    v_and_b32 v133, 0xffff0000, v8
    v_lshlrev_b32 v134, 16, v9
    v_and_b32 v135, 0xffff0000, v9
    v_mul_f32 v132, -v132, v128
    v_mul_f32 v133, -v133, v129
    v_mul_f32 v134, -v134, v130
    v_mul_f32 v135, -v135, v131
    ds_write_b128 v1, v[128:131] offset:4096
    ds_write_b128 v1, v[132:135] offset:12288
    s_mov_b32 s14, 0
    s_mov_b32 s15, 0
    s_waitcnt lgkmcnt(0)
    s_barrier
L1a_cloop:
    s_barrier
    v_add_u32 v22, s14, v20
    v_add_u32 v23, s14, v21
    s_add_u32 s14, s14, 12288
    s_cmp_ge_u32 s14, 49152
    s_cselect_b32 s14, 0, s14
    ds_read_b128 v[48:51], v18 offset:0
    ds_read_b128 v[52:55], v18 offset:2048
    v_mfma_f32_16x16x32_bf16 v[24:27], v[88:91], v[104:107], v[24:27]
    ds_read_b64_tr_b16 v[64:65], v22 offset:49152
    ds_read_b64_tr_b16 v[66:67], v22 offset:49920
    v_mfma_f32_16x16x32_bf16 v[36:39], v[92:95], v[104:107], v[36:39]
    ds_read_b64_tr_b16 v[68:69], v22 offset:49184
    ds_read_b64_tr_b16 v[70:71], v22 offset:49952
    v_mfma_f32_16x16x32_bf16 v[28:31], v[88:91], v[108:111], v[28:31]
    ds_read_b64_tr_b16 v[72:73], v23 offset:49216
    ds_read_b64_tr_b16 v[74:75], v23 offset:49984
    v_mfma_f32_16x16x32_bf16 v[40:43], v[92:95], v[108:111], v[40:43]
    ds_read_b128 v[56:59], v19 offset:0
    ds_read_b128 v[60:63], v19 offset:2048
    v_mfma_f32_16x16x32_bf16 v[32:35], v[88:91], v[112:115], v[32:35]
    ds_read_b64_tr_b16 v[76:77], v22 offset:55296
    ds_read_b64_tr_b16 v[78:79], v22 offset:56064
    v_mfma_f32_16x16x32_bf16 v[44:47], v[92:95], v[112:115], v[44:47]
    ds_read_b64_tr_b16 v[80:81], v22 offset:55328
    ds_read_b64_tr_b16 v[82:83], v22 offset:56096
    v_mfma_f32_16x16x32_bf16 v[24:27], v[96:99], v[116:119], v[24:27]
    ds_read_b64_tr_b16 v[84:85], v23 offset:55360
    ds_read_b64_tr_b16 v[86:87], v23 offset:56128
    v_mfma_f32_16x16x32_bf16 v[36:39], v[100:103], v[116:119], v[36:39]
    v_mfma_f32_16x16x32_bf16 v[28:31], v[96:99], v[120:123], v[28:31]
    v_mfma_f32_16x16x32_bf16 v[40:43], v[100:103], v[120:123], v[40:43]
    v_mfma_f32_16x16x32_bf16 v[32:35], v[96:99], v[124:127], v[32:35]
    v_mfma_f32_16x16x32_bf16 v[44:47], v[100:103], v[124:127], v[44:47]
    s_xor_b32 s13, s15, 4
    s_or_b32 s13, s13, s4
    s_cmp_lg_u32 s13, 0
    s_cbranch_scc1 L1a_nip
    s_mov_b32 s56, s30
    s_and_b32 s57, s31, 0xffff
    s_mov_b32 s58, 256
    s_mov_b32 s59, 0x00020000
    v_mov_b32 v10, 0
    buffer_load_dword v7, v10, s[56:59], 0 offen sc1
L1a_nip:
    s_xor_b32 s13, s15, 2
    s_or_b32 s13, s13, s4
    s_cmp_lg_u32 s13, 0
    s_cbranch_scc1 L1a_nprb1
    s_mov_b32 s56, s30
    s_and_b32 s57, s31, 0xffff
    s_mov_b32 s58, 256
    s_mov_b32 s59, 0x00020000
    v_mov_b32 v10, 0
    s_lshl_b32 s61, s8, 2
    buffer_load_dword v6, v10, s[56:59], s61 offen offset:128 sc1
L1a_nprb1:
    s_xor_b32 s13, s15, 4
    s_or_b32 s13, s13, s4
    s_cmp_lg_u32 s13, 0
    s_cbranch_scc1 L1a_nprb2
    s_mov_b32 s56, s30
    s_and_b32 s57, s31, 0xffff
    s_mov_b32 s58, 256
    s_mov_b32 s59, 0x00020000
    v_mov_b32 v10, 0
    s_lshl_b32 s61, s8, 2
    buffer_load_dword v6, v10, s[56:59], s61 offen offset:192 sc1
L1a_nprb2:
    s_waitcnt lgkmcnt(0)
    s_barrier
    v_add_u32 v22, s14, v20
    v_add_u32 v23, s14, v21
    s_add_u32 s14, s14, 12288
    s_cmp_ge_u32 s14, 49152
    s_cselect_b32 s14, 0, s14
    ds_read_b128 v[88:91], v18 offset:8192
    ds_read_b128 v[92:95], v18 offset:10240
    v_mfma_f32_16x16x32_bf16 v[24:27], v[48:51], v[64:67], v[24:27]
    ds_read_b64_tr_b16 v[104:105], v22 offset:49152
    ds_read_b64_tr_b16 v[106:107], v22 offset:49920
    v_mfma_f32_16x16x32_bf16 v[36:39], v[52:55], v[64:67], v[36:39]
    ds_read_b64_tr_b16 v[108:109], v22 offset:49184
    ds_read_b64_tr_b16 v[110:111], v22 offset:49952
    v_mfma_f32_16x16x32_bf16 v[28:31], v[48:51], v[68:71], v[28:31]
    ds_read_b64_tr_b16 v[112:113], v23 offset:49216
    ds_read_b64_tr_b16 v[114:115], v23 offset:49984
    v_mfma_f32_16x16x32_bf16 v[40:43], v[52:55], v[68:71], v[40:43]
    ds_read_b128 v[96:99], v19 offset:8192
    ds_read_b128 v[100:103], v19 offset:10240
    v_mfma_f32_16x16x32_bf16 v[32:35], v[48:51], v[72:75], v[32:35]
    ds_read_b64_tr_b16 v[116:117], v22 offset:55296
    ds_read_b64_tr_b16 v[118:119], v22 offset:56064
    v_mfma_f32_16x16x32_bf16 v[44:47], v[52:55], v[72:75], v[44:47]
    ds_read_b64_tr_b16 v[120:121], v22 offset:55328
    ds_read_b64_tr_b16 v[122:123], v22 offset:56096
    v_mfma_f32_16x16x32_bf16 v[24:27], v[56:59], v[76:79], v[24:27]
    ds_read_b64_tr_b16 v[124:125], v23 offset:55360
    ds_read_b64_tr_b16 v[126:127], v23 offset:56128
    v_mfma_f32_16x16x32_bf16 v[36:39], v[60:63], v[76:79], v[36:39]
    v_mfma_f32_16x16x32_bf16 v[28:31], v[56:59], v[80:83], v[28:31]
    v_mfma_f32_16x16x32_bf16 v[40:43], v[60:63], v[80:83], v[40:43]
    v_mfma_f32_16x16x32_bf16 v[32:35], v[56:59], v[84:87], v[32:35]
    v_mfma_f32_16x16x32_bf16 v[44:47], v[60:63], v[84:87], v[44:47]
    s_xor_b32 s13, s15, 1
    s_or_b32 s13, s13, s4
    s_cmp_lg_u32 s13, 0
    s_cbranch_scc1 L1a_nprb0
    s_mov_b32 s56, s30
    s_and_b32 s57, s31, 0xffff
    s_mov_b32 s58, 256
    s_mov_b32 s59, 0x00020000
    v_mov_b32 v10, 0
    s_lshl_b32 s61, s8, 2
    buffer_load_dword v6, v10, s[56:59], s61 offen offset:64 sc1
L1a_nprb0:
    s_xor_b32 s13, s15, 2
    s_or_b32 s13, s13, s4
    s_cmp_lg_u32 s13, 0
    s_cbranch_scc1 L1a_nchk1
    s_waitcnt vmcnt(0)
    v_readfirstlane_b32 s62, v6
    s_cmp_ge_u32 s62, 8
    s_cbranch_scc1 L1a_nchk1
    s_mov_b32 s56, s30
    s_and_b32 s57, s31, 0xffff
    s_mov_b32 s58, 256
    s_mov_b32 s59, 0x00020000
    v_mov_b32 v10, 0
    s_lshl_b32 s61, s8, 2
    s_mov_b32 s13, 0
L1a_chk1:
    buffer_load_dword v6, v10, s[56:59], s61 offen offset:128 sc1
    s_waitcnt vmcnt(0)
    v_readfirstlane_b32 s62, v6
    s_add_u32 s13, s13, 1
    s_cmp_ge_u32 s62, 8
    s_cbranch_scc1 L1a_chk1_ok
    s_sleep 8
    s_cmp_lt_u32 s13, 0x40000
    s_cbranch_scc1 L1a_chk1
L1a_chk1_ok:
L1a_nchk1:
    s_xor_b32 s13, s15, 4
    s_or_b32 s13, s13, s4
    s_cmp_lg_u32 s13, 0
    s_cbranch_scc1 L1a_nchk2
    s_waitcnt vmcnt(0)
    v_readfirstlane_b32 s62, v6
    s_cmp_ge_u32 s62, 3
    s_cbranch_scc1 L1a_nchk2
    s_mov_b32 s56, s30
    s_and_b32 s57, s31, 0xffff
    s_mov_b32 s58, 256
    s_mov_b32 s59, 0x00020000
    v_mov_b32 v10, 0
    s_lshl_b32 s61, s8, 2
    s_mov_b32 s13, 0
L1a_chk2:
    buffer_load_dword v6, v10, s[56:59], s61 offen offset:192 sc1
    s_waitcnt vmcnt(0)
    v_readfirstlane_b32 s62, v6
    s_add_u32 s13, s13, 1
    s_cmp_ge_u32 s62, 3
    s_cbranch_scc1 L1a_chk2_ok
    s_sleep 8
    s_cmp_lt_u32 s13, 0x40000
    s_cbranch_scc1 L1a_chk2
L1a_chk2_ok:
L1a_nchk2:
    s_waitcnt lgkmcnt(0)
    s_barrier
    v_add_u32 v22, s14, v20
    v_add_u32 v23, s14, v21
    s_add_u32 s14, s14, 12288
    s_cmp_ge_u32 s14, 49152
    s_cselect_b32 s14, 0, s14
    ds_read_b128 v[48:51], v18 offset:16384
    ds_read_b128 v[52:55], v18 offset:18432
    v_mfma_f32_16x16x32_bf16 v[24:27], v[88:91], v[104:107], v[24:27]
    ds_read_b64_tr_b16 v[64:65], v22 offset:49152
    ds_read_b64_tr_b16 v[66:67], v22 offset:49920
    v_mfma_f32_16x16x32_bf16 v[36:39], v[92:95], v[104:107], v[36:39]
    ds_read_b64_tr_b16 v[68:69], v22 offset:49184
    ds_read_b64_tr_b16 v[70:71], v22 offset:49952
    v_mfma_f32_16x16x32_bf16 v[28:31], v[88:91], v[108:111], v[28:31]
    ds_read_b64_tr_b16 v[72:73], v23 offset:49216
    ds_read_b64_tr_b16 v[74:75], v23 offset:49984
    v_mfma_f32_16x16x32_bf16 v[40:43], v[92:95], v[108:111], v[40:43]
    ds_read_b128 v[56:59], v19 offset:16384
    ds_read_b128 v[60:63], v19 offset:18432
    v_mfma_f32_16x16x32_bf16 v[32:35], v[88:91], v[112:115], v[32:35]
    ds_read_b64_tr_b16 v[76:77], v22 offset:55296
    ds_read_b64_tr_b16 v[78:79], v22 offset:56064
    v_mfma_f32_16x16x32_bf16 v[44:47], v[92:95], v[112:115], v[44:47]
    ds_read_b64_tr_b16 v[80:81], v22 offset:55328
    ds_read_b64_tr_b16 v[82:83], v22 offset:56096
    v_mfma_f32_16x16x32_bf16 v[24:27], v[96:99], v[116:119], v[24:27]
    ds_read_b64_tr_b16 v[84:85], v23 offset:55360
    ds_read_b64_tr_b16 v[86:87], v23 offset:56128
    v_mfma_f32_16x16x32_bf16 v[36:39], v[100:103], v[116:119], v[36:39]
    v_mfma_f32_16x16x32_bf16 v[28:31], v[96:99], v[120:123], v[28:31]
    v_mfma_f32_16x16x32_bf16 v[40:43], v[100:103], v[120:123], v[40:43]
    v_mfma_f32_16x16x32_bf16 v[32:35], v[96:99], v[124:127], v[32:35]
    v_mfma_f32_16x16x32_bf16 v[44:47], v[100:103], v[124:127], v[44:47]
    s_xor_b32 s13, s15, 1
    s_or_b32 s13, s13, s4
    s_cmp_lg_u32 s13, 0
    s_cbranch_scc1 L1a_nchk0
    s_waitcnt vmcnt(0)
    v_readfirstlane_b32 s62, v6
    s_cmp_ge_u32 s62, 3
    s_cbranch_scc1 L1a_nchk0
    s_mov_b32 s56, s30
    s_and_b32 s57, s31, 0xffff
    s_mov_b32 s58, 256
    s_mov_b32 s59, 0x00020000
    v_mov_b32 v10, 0
    s_lshl_b32 s61, s8, 2
    s_mov_b32 s13, 0
L1a_chk0:
    buffer_load_dword v6, v10, s[56:59], s61 offen offset:64 sc1
    s_waitcnt vmcnt(0)
    v_readfirstlane_b32 s62, v6
    s_add_u32 s13, s13, 1
    s_cmp_ge_u32 s62, 3
    s_cbranch_scc1 L1a_chk0_ok
    s_sleep 8
    s_cmp_lt_u32 s13, 0x40000
    s_cbranch_scc1 L1a_chk0
L1a_chk0_ok:
L1a_nchk0:
    s_waitcnt lgkmcnt(0)
    s_barrier
    v_add_u32 v22, s14, v20
    v_add_u32 v23, s14, v21
    s_add_u32 s14, s14, 12288
    s_cmp_ge_u32 s14, 49152
    s_cselect_b32 s14, 0, s14
    ds_read_b128 v[88:91], v18 offset:24576
    ds_read_b128 v[92:95], v18 offset:26624
    v_mfma_f32_16x16x32_bf16 v[24:27], v[48:51], v[64:67], v[24:27]
    ds_read_b64_tr_b16 v[104:105], v22 offset:49152
    ds_read_b64_tr_b16 v[106:107], v22 offset:49920
    v_mfma_f32_16x16x32_bf16 v[36:39], v[52:55], v[64:67], v[36:39]
    ds_read_b64_tr_b16 v[108:109], v22 offset:49184
    ds_read_b64_tr_b16 v[110:111], v22 offset:49952
    v_mfma_f32_16x16x32_bf16 v[28:31], v[48:51], v[68:71], v[28:31]
    ds_read_b64_tr_b16 v[112:113], v23 offset:49216
    ds_read_b64_tr_b16 v[114:115], v23 offset:49984
    v_mfma_f32_16x16x32_bf16 v[40:43], v[52:55], v[68:71], v[40:43]
    ds_read_b128 v[96:99], v19 offset:24576
    ds_read_b128 v[100:103], v19 offset:26624
    v_mfma_f32_16x16x32_bf16 v[32:35], v[48:51], v[72:75], v[32:35]
    ds_read_b64_tr_b16 v[116:117], v22 offset:55296
    ds_read_b64_tr_b16 v[118:119], v22 offset:56064
    v_mfma_f32_16x16x32_bf16 v[44:47], v[52:55], v[72:75], v[44:47]
    ds_read_b64_tr_b16 v[120:121], v22 offset:55328
    ds_read_b64_tr_b16 v[122:123], v22 offset:56096
    v_mfma_f32_16x16x32_bf16 v[24:27], v[56:59], v[76:79], v[24:27]
    ds_read_b64_tr_b16 v[124:125], v23 offset:55360
    ds_read_b64_tr_b16 v[126:127], v23 offset:56128
    v_mfma_f32_16x16x32_bf16 v[36:39], v[60:63], v[76:79], v[36:39]
    v_mfma_f32_16x16x32_bf16 v[28:31], v[56:59], v[80:83], v[28:31]
    v_mfma_f32_16x16x32_bf16 v[40:43], v[60:63], v[80:83], v[40:43]
    v_mfma_f32_16x16x32_bf16 v[32:35], v[56:59], v[84:87], v[32:35]
    v_mfma_f32_16x16x32_bf16 v[44:47], v[60:63], v[84:87], v[44:47]
    s_xor_b32 s13, s15, 4
    s_or_b32 s13, s13, s4
    s_cmp_lg_u32 s13, 0
    s_cbranch_scc1 L1a_iok
    s_waitcnt vmcnt(0)
    v_readfirstlane_b32 s62, v7
    s_cmp_ge_u32 s62, 96
    s_cbranch_scc1 L1a_iok
    s_mov_b32 s56, s30
    s_and_b32 s57, s31, 0xffff
    s_mov_b32 s58, 256
    s_mov_b32 s59, 0x00020000
    v_mov_b32 v10, 0
    s_mov_b32 s63, 0
L1a_ichk:
    buffer_load_dword v7, v10, s[56:59], 0 offen sc1
    s_waitcnt vmcnt(0)
    v_readfirstlane_b32 s62, v7
    s_add_u32 s63, s63, 1
    s_cmp_ge_u32 s62, 96
    s_cbranch_scc1 L1a_ichk_ok
    s_sleep 8
    s_cmp_lt_u32 s63, 0x40000
    s_cbranch_scc1 L1a_ichk
L1a_ichk_ok:
L1a_iok:
    s_waitcnt lgkmcnt(0)
    s_add_u32 s15, s15, 1
    s_cmp_lt_u32 s15, 6
    s_cbranch_scc1 L1a_cloop
    s_mov_b32 s48, s30
    s_and_b32 s49, s31, 0xffff
    s_mov_b32 s50, 256
    s_mov_b32 s51, 0x00020000
    v_mov_b32 v2, 0
    buffer_load_dword v5, v2, s[48:51], 0 offen sc1
    s_barrier
    v_mfma_f32_16x16x32_bf16 v[24:27], v[88:91], v[104:107], v[24:27]
    v_mfma_f32_16x16x32_bf16 v[36:39], v[92:95], v[104:107], v[36:39]
    v_mfma_f32_16x16x32_bf16 v[28:31], v[88:91], v[108:111], v[28:31]
    v_mfma_f32_16x16x32_bf16 v[40:43], v[92:95], v[108:111], v[40:43]
    v_mfma_f32_16x16x32_bf16 v[32:35], v[88:91], v[112:115], v[32:35]
    v_mfma_f32_16x16x32_bf16 v[44:47], v[92:95], v[112:115], v[44:47]
    v_mfma_f32_16x16x32_bf16 v[24:27], v[96:99], v[116:119], v[24:27]
    v_mfma_f32_16x16x32_bf16 v[36:39], v[100:103], v[116:119], v[36:39]
    v_mfma_f32_16x16x32_bf16 v[28:31], v[96:99], v[120:123], v[28:31]
    v_mfma_f32_16x16x32_bf16 v[40:43], v[100:103], v[120:123], v[40:43]
    v_mfma_f32_16x16x32_bf16 v[32:35], v[96:99], v[124:127], v[32:35]
    v_mfma_f32_16x16x32_bf16 v[44:47], v[100:103], v[124:127], v[44:47]
    v_and_b32 v22, 1, v17
    v_lshrrev_b32 v23, 1, v17
    v_lshlrev_b32 v1, 4, v16
    v_lshl_add_u32 v1, v22, 9, v1
    v_lshl_add_u32 v1, v23, 10, v1
    s_mul_i32 s13, s7, 60
    s_lshl_b32 s14, s8, 1
    s_add_u32 s13, s13, s14
    s_add_u32 s13, s13, s11
    s_lshl_b32 s13, s13, 11
    s_mul_i32 s14, s12, 3
    s_add_u32 s14, s14, 0
    s_lshr_b32 s15, s14, 1
    s_mul_i32 s15, s15, 40960
    s_and_b32 s14, s14, 1
    s_lshl_b32 s14, s14, 8
    s_add_u32 s14, s14, s15
    s_add_u32 s14, s14, s13
    s_nop 3
    v_cvt_pk_bf16_f32 v48, v24, v25
    v_cvt_pk_bf16_f32 v49, v26, v27
    v_cvt_pk_bf16_f32 v50, v36, v37
    v_cvt_pk_bf16_f32 v51, v38, v39
    s_nop 1
    v_permlane32_swap_b32 v48, v50
    v_permlane32_swap_b32 v49, v51
    buffer_store_dwordx4 v[48:51], v1, s[44:47], s14 offen sc1
    s_mul_i32 s14, s12, 3
    s_add_u32 s14, s14, 1
    s_lshr_b32 s15, s14, 1
    s_mul_i32 s15, s15, 40960
    s_and_b32 s14, s14, 1
    s_lshl_b32 s14, s14, 8
    s_add_u32 s14, s14, s15
    s_add_u32 s14, s14, s13
    v_cvt_pk_bf16_f32 v52, v28, v29
    v_cvt_pk_bf16_f32 v53, v30, v31
    v_cvt_pk_bf16_f32 v54, v40, v41
    v_cvt_pk_bf16_f32 v55, v42, v43
    s_nop 1
    v_permlane32_swap_b32 v52, v54
    v_permlane32_swap_b32 v53, v55
    buffer_store_dwordx4 v[52:55], v1, s[44:47], s14 offen sc1
    s_mul_i32 s14, s12, 3
    s_add_u32 s14, s14, 2
    s_lshr_b32 s15, s14, 1
    s_mul_i32 s15, s15, 40960
    s_and_b32 s14, s14, 1
    s_lshl_b32 s14, s14, 8
    s_add_u32 s14, s14, s15
    s_add_u32 s14, s14, s13
    v_cvt_pk_bf16_f32 v56, v32, v33
    v_cvt_pk_bf16_f32 v57, v34, v35
    v_cvt_pk_bf16_f32 v58, v44, v45
    v_cvt_pk_bf16_f32 v59, v46, v47
    s_nop 1
    v_permlane32_swap_b32 v56, v58
    v_permlane32_swap_b32 v57, v59
    buffer_store_dwordx4 v[56:59], v1, s[44:47], s14 offen sc1
    v_mov_b32 v3, 1
    v_mov_b32 v2, 131072
    s_waitcnt vmcnt(0)
    s_mov_b64 exec, 1
    ds_add_rtn_u32 v4, v2, v3
    s_mov_b64 exec, -1
    s_waitcnt lgkmcnt(0)
    v_readfirstlane_b32 s14, v4
    s_cmp_lg_u32 s14, 3
    s_cbranch_scc1 Lsig_t_done
    v_readfirstlane_b32 s14, v5
    v_mov_b32 v2, 0
    s_cmp_ge_u32 s14, 96
    s_cbranch_scc1 Lsig_t_init_ok
    s_mov_b32 s15, 0
Lsig_t_init:
    buffer_load_dword v4, v2, s[48:51], 0 offen sc1
    s_waitcnt vmcnt(0)
    v_readfirstlane_b32 s14, v4
    s_add_u32 s15, s15, 1
    s_cmp_ge_u32 s14, 96
    s_cbranch_scc1 Lsig_t_init_ok
    s_sleep 8
    s_cmp_lt_u32 s15, 0x40000
    s_cbranch_scc1 Lsig_t_init
Lsig_t_init_ok:
    s_add_u32 s48, s32, 6291456
    s_addc_u32 s49, s33, 0
    s_and_b32 s49, s49, 0xffff
    s_mov_b32 s50, 32768
    s_mov_b32 s51, 0x00020000
    v_lshrrev_b32 v2, 2, v0
    v_and_b32 v4, 3, v0
    s_lshr_b32 s14, s7, 3
    s_and_b32 s15, s7, 7
    s_lshl_b32 s15, s15, 5
    s_add_u32 s14, s14, s15
    v_lshlrev_b32 v2, 1, v2
    v_lshl_add_u32 v2, v4, 3, v2
    v_add_u32 v2, s14, v2
    v_lshlrev_b32 v2, 7, v2
    s_mov_b64 exec, 0xffff
    buffer_atomic_add v3, v2, s[48:51], 0 offen offset:4 sc1
    s_mov_b64 exec, -1
Lsig_t_done:
    s_branch L2_comp
L1b:
    v_lshlrev_b32 v136, 4, v0
    v_lshrrev_b32 v137, 4, v0
    v_mul_u32_u24 v137, 6144, v137
    v_and_b32 v138, 15, v0
    v_lshl_add_u32 v137, v138, 4, v137
    s_waitcnt lgkmcnt(0)
    s_cmp_lg_u32 s4, 7
    s_cbranch_scc1 L1b_nz
    s_add_u32 s56, s32, 6291456
    s_addc_u32 s57, s33, 0
    s_and_b32 s57, s57, 0xffff
    s_mov_b32 s58, 32768
    s_mov_b32 s59, 0x00020000
    v_mov_b32 v132, 0
    v_lshlrev_b32 v133, 2, v0
    s_mul_i32 s60, s5, 12
    s_add_u32 s60, s60, s6
    s_sub_u32 s60, s60, 20
    s_lshl_b32 s60, s60, 7
    s_mov_b32 exec_hi, 0
    buffer_store_dword v132, v133, s[56:59], s60 offen sc1
    s_add_u32 s60, s60, 12288
    buffer_store_dword v132, v133, s[56:59], s60 offen sc1
    s_add_u32 s60, s60, 12288
    buffer_store_dword v132, v133, s[56:59], s60 offen sc1
    s_add_u32 s60, s60, 12288
    s_mov_b64 exec, -1
    v_mov_b32 v10, 0
    v_mov_b32 v11, 131072
    ds_write_b32 v11, v10
    s_waitcnt vmcnt(0)
    s_mov_b32 s56, s30
    s_and_b32 s57, s31, 0xffff
    s_mov_b32 s58, 256
    s_mov_b32 s59, 0x00020000
    v_mov_b32 v132, 0
    v_mov_b32 v133, 1
    s_mov_b64 exec, 1
    buffer_atomic_add v133, v132, s[56:59], 0 offen sc1
    s_mov_b64 exec, -1
L1b_nz:
    s_mov_b32 s40, s26
    s_and_b32 s41, s27, 0xffff
    s_mov_b32 s42, 4718592
    s_mov_b32 s43, 0x00020000
    s_mov_b32 s36, s18
    s_and_b32 s37, s19, 0xffff
    s_mov_b32 s38, 3932160
    s_mov_b32 s39, 0x00020000
    s_cmp_lt_u32 s6, 30
    s_cbranch_scc1 L1b_pf
    s_lshl_b32 s13, s5, 1
    s_add_u32 s13, s13, s6
    s_sub_u32 s13, s13, 30
    s_lshl_b32 s13, s13, 3
    s_add_u32 s13, s13, s4
    s_mov_b32 s44, s20
    s_and_b32 s45, s21, 0xffff
    s_mov_b32 s46, 3072
    s_mov_b32 s47, 0x00020000
    s_mov_b32 s48, s22
    s_and_b32 s49, s23, 0xffff
    s_mov_b32 s50, 3072
    s_mov_b32 s51, 0x00020000
    v_lshrrev_b32 v2, 3, v0
    v_and_b32 v3, 7, v0
    v_mul_u32_u24 v4, 6144, v2
    v_lshl_add_u32 v4, v3, 5, v4
    v_add_u32 v5, 49152, v4
    v_lshlrev_b32 v6, 4, v3
    s_mov_b32 s53, s13
    s_mul_i32 s15, s53, 1639
    s_lshr_b32 s15, s15, 16
    s_mul_i32 s34, s15, 40
    s_sub_u32 s34, s53, s34
    s_add_u32 s15, s15, 10
    s_lshr_b32 s68, s34, 2
    s_lshl_b32 s34, s34, 4
    s_mul_i32 s35, s34, 6144
    s_lshl_b32 s52, s15, 8
    s_add_u32 s35, s35, s52
    buffer_load_dwordx4 v[8:11], v4, s[36:39], s35 offen
    buffer_load_dwordx4 v[12:15], v4, s[36:39], s35 offen offset:16
    buffer_load_dwordx4 v[16:19], v5, s[36:39], s35 offen
    buffer_load_dwordx4 v[20:23], v5, s[36:39], s35 offen offset:16
    s_lshl_b32 s52, s15, 7
    buffer_load_dwordx4 v[24:27], v6, s[44:47], s52 offen
    buffer_load_dwordx4 v[28:31], v6, s[48:51], s52 offen
    s_mul_i32 s52, s68, 24
    s_add_u32 s52, s52, s15
    s_lshl_b32 s52, s52, 13
    s_and_b32 s34, s34, 63
    s_lshl_b32 s34, s34, 7
    s_add_u32 s64, s52, s34
    s_cmp_lt_u32 s15, 13
    s_cselect_b32 s72, 64, 128
    s_cmp_lt_u32 s15, 21
    s_cselect_b32 s72, s72, 192
    s_add_u32 s54, s13, 448
    s_cmp_ge_u32 s54, 560
    s_cselect_b32 s54, s53, s54
    s_mul_i32 s15, s54, 1639
    s_lshr_b32 s15, s15, 16
    s_mul_i32 s34, s15, 40
    s_sub_u32 s34, s54, s34
    s_add_u32 s15, s15, 10
    s_lshr_b32 s69, s34, 2
    s_lshl_b32 s34, s34, 4
    s_mul_i32 s35, s34, 6144
    s_lshl_b32 s52, s15, 8
    s_add_u32 s35, s35, s52
    buffer_load_dwordx4 v[32:35], v4, s[36:39], s35 offen
    buffer_load_dwordx4 v[36:39], v4, s[36:39], s35 offen offset:16
    buffer_load_dwordx4 v[40:43], v5, s[36:39], s35 offen
    buffer_load_dwordx4 v[44:47], v5, s[36:39], s35 offen offset:16
    s_lshl_b32 s52, s15, 7
    buffer_load_dwordx4 v[48:51], v6, s[44:47], s52 offen
    buffer_load_dwordx4 v[52:55], v6, s[48:51], s52 offen
    s_mul_i32 s52, s69, 24
    s_add_u32 s52, s52, s15
    s_lshl_b32 s52, s52, 13
    s_and_b32 s34, s34, 63
    s_lshl_b32 s34, s34, 7
    s_add_u32 s65, s52, s34
    s_cmp_lt_u32 s15, 13
    s_cselect_b32 s73, 64, 128
    s_cmp_lt_u32 s15, 21
    s_cselect_b32 s73, s73, 192
    v_lshrrev_b32 v7, 4, v0
    v_xor_b32 v7, v3, v7
    v_xor_b32 v3, 4, v7
    v_lshlrev_b32 v2, 7, v2
    v_lshl_add_u32 v3, v3, 4, v2
    v_add_u32 v3, 1024, v3
    v_lshl_add_u32 v2, v7, 4, v2
    s_add_u32 s44, s32, 7340032
    s_addc_u32 s45, s33, 0
    s_and_b32 s45, s45, 0xffff
    s_mov_b32 s46, 1966080
    s_mov_b32 s47, 0x00020000
    v_lshlrev_b32 v128, 2, v0
    v_mov_b32 v129, 1
    s_waitcnt vmcnt(6)
    v_lshlrev_b32 v112, 16, v24
    v_and_b32 v113, 0xffff0000, v24
    v_lshlrev_b32 v120, 16, v28
    v_and_b32 v121, 0xffff0000, v28
    v_lshlrev_b32 v114, 16, v25
    v_and_b32 v115, 0xffff0000, v25
    v_lshlrev_b32 v122, 16, v29
    v_and_b32 v123, 0xffff0000, v29
    v_lshlrev_b32 v116, 16, v26
    v_and_b32 v117, 0xffff0000, v26
    v_lshlrev_b32 v124, 16, v30
    v_and_b32 v125, 0xffff0000, v30
    v_lshlrev_b32 v118, 16, v27
    v_and_b32 v119, 0xffff0000, v27
    v_lshlrev_b32 v126, 16, v31
    v_and_b32 v127, 0xffff0000, v31
    v_mul_f32 v120, -v120, v112
    v_mul_f32 v121, -v121, v113
    v_mul_f32 v122, -v122, v114
    v_mul_f32 v123, -v123, v115
    v_mul_f32 v124, -v124, v116
    v_mul_f32 v125, -v125, v117
    v_mul_f32 v126, -v126, v118
    v_mul_f32 v127, -v127, v119
    v_cvt_f32_i32 v8, v8
    v_cvt_f32_i32 v9, v9
    v_cvt_f32_i32 v10, v10
    v_cvt_f32_i32 v11, v11
    v_cvt_f32_i32 v12, v12
    v_cvt_f32_i32 v13, v13
    v_cvt_f32_i32 v14, v14
    v_cvt_f32_i32 v15, v15
    v_fma_f32 v8, v8, v112, v120
    v_fma_f32 v9, v9, v113, v121
    v_fma_f32 v10, v10, v114, v122
    v_fma_f32 v11, v11, v115, v123
    v_fma_f32 v12, v12, v116, v124
    v_fma_f32 v13, v13, v117, v125
    v_fma_f32 v14, v14, v118, v126
    v_fma_f32 v15, v15, v119, v127
    v_cvt_pk_bf16_f32 v8, v8, v9
    v_cvt_pk_bf16_f32 v9, v10, v11
    v_cvt_pk_bf16_f32 v10, v12, v13
    v_cvt_pk_bf16_f32 v11, v14, v15
    buffer_store_dwordx4 v[8:11], v2, s[44:47], s64 offen sc1
    v_cvt_f32_i32 v16, v16
    v_cvt_f32_i32 v17, v17
    v_cvt_f32_i32 v18, v18
    v_cvt_f32_i32 v19, v19
    v_cvt_f32_i32 v20, v20
    v_cvt_f32_i32 v21, v21
    v_cvt_f32_i32 v22, v22
    v_cvt_f32_i32 v23, v23
    v_fma_f32 v16, v16, v112, v120
    v_fma_f32 v17, v17, v113, v121
    v_fma_f32 v18, v18, v114, v122
    v_fma_f32 v19, v19, v115, v123
    v_fma_f32 v20, v20, v116, v124
    v_fma_f32 v21, v21, v117, v125
    v_fma_f32 v22, v22, v118, v126
    v_fma_f32 v23, v23, v119, v127
    v_cvt_pk_bf16_f32 v16, v16, v17
    v_cvt_pk_bf16_f32 v17, v18, v19
    v_cvt_pk_bf16_f32 v18, v20, v21
    v_cvt_pk_bf16_f32 v19, v22, v23
    buffer_store_dwordx4 v[16:19], v3, s[44:47], s64 offen sc1
    s_waitcnt vmcnt(2)
    v_lshlrev_b32 v112, 16, v48
    v_and_b32 v113, 0xffff0000, v48
    v_lshlrev_b32 v120, 16, v52
    v_and_b32 v121, 0xffff0000, v52
    v_lshlrev_b32 v114, 16, v49
    v_and_b32 v115, 0xffff0000, v49
    v_lshlrev_b32 v122, 16, v53
    v_and_b32 v123, 0xffff0000, v53
    v_lshlrev_b32 v116, 16, v50
    v_and_b32 v117, 0xffff0000, v50
    v_lshlrev_b32 v124, 16, v54
    v_and_b32 v125, 0xffff0000, v54
    v_lshlrev_b32 v118, 16, v51
    v_and_b32 v119, 0xffff0000, v51
    v_lshlrev_b32 v126, 16, v55
    v_and_b32 v127, 0xffff0000, v55
    v_mul_f32 v120, -v120, v112
    v_mul_f32 v121, -v121, v113
    v_mul_f32 v122, -v122, v114
    v_mul_f32 v123, -v123, v115
    v_mul_f32 v124, -v124, v116
    v_mul_f32 v125, -v125, v117
    v_mul_f32 v126, -v126, v118
    v_mul_f32 v127, -v127, v119
    v_cvt_f32_i32 v32, v32
    v_cvt_f32_i32 v33, v33
    v_cvt_f32_i32 v34, v34
    v_cvt_f32_i32 v35, v35
    v_cvt_f32_i32 v36, v36
    v_cvt_f32_i32 v37, v37
    v_cvt_f32_i32 v38, v38
    v_cvt_f32_i32 v39, v39
    v_fma_f32 v32, v32, v112, v120
    v_fma_f32 v33, v33, v113, v121
    v_fma_f32 v34, v34, v114, v122
    v_fma_f32 v35, v35, v115, v123
    v_fma_f32 v36, v36, v116, v124
    v_fma_f32 v37, v37, v117, v125
    v_fma_f32 v38, v38, v118, v126
    v_fma_f32 v39, v39, v119, v127
    v_cvt_pk_bf16_f32 v32, v32, v33
    v_cvt_pk_bf16_f32 v33, v34, v35
    v_cvt_pk_bf16_f32 v34, v36, v37
    v_cvt_pk_bf16_f32 v35, v38, v39
    buffer_store_dwordx4 v[32:35], v2, s[44:47], s65 offen sc1
    v_cvt_f32_i32 v40, v40
    v_cvt_f32_i32 v41, v41
    v_cvt_f32_i32 v42, v42
    v_cvt_f32_i32 v43, v43
    v_cvt_f32_i32 v44, v44
    v_cvt_f32_i32 v45, v45
    v_cvt_f32_i32 v46, v46
    v_cvt_f32_i32 v47, v47
    v_fma_f32 v40, v40, v112, v120
    v_fma_f32 v41, v41, v113, v121
    v_fma_f32 v42, v42, v114, v122
    v_fma_f32 v43, v43, v115, v123
    v_fma_f32 v44, v44, v116, v124
    v_fma_f32 v45, v45, v117, v125
    v_fma_f32 v46, v46, v118, v126
    v_fma_f32 v47, v47, v119, v127
    v_cvt_pk_bf16_f32 v40, v40, v41
    v_cvt_pk_bf16_f32 v41, v42, v43
    v_cvt_pk_bf16_f32 v42, v44, v45
    v_cvt_pk_bf16_f32 v43, v46, v47
    buffer_store_dwordx4 v[40:43], v3, s[44:47], s65 offen sc1
    s_mov_b32 s48, s30
    s_and_b32 s49, s31, 0xffff
    s_mov_b32 s50, 256
    s_mov_b32 s51, 0x00020000
    s_waitcnt vmcnt(0)
    s_barrier
    s_cmp_lg_u32 s4, 0
    s_cbranch_scc1 L_h_s1
    s_lshl_b32 s14, s68, 2
    s_add_u32 s14, s14, s72
    s_mov_b64 exec, 3
    buffer_atomic_add v129, v128, s[48:51], s14 offen sc1
    s_mov_b64 exec, -1
    s_cmp_eq_u32 s54, s53
    s_cbranch_scc1 L_h_s1
    s_lshl_b32 s14, s69, 2
    s_add_u32 s14, s14, s73
    s_mov_b64 exec, 3
    buffer_atomic_add v129, v128, s[48:51], s14 offen sc1
    s_mov_b64 exec, -1
L_h_s1:
    s_mov_b32 s55, s13
L_pfi_loop:
    s_mul_i32 s48, s55, 2979
    s_lshr_b32 s48, s48, 20
    s_mul_i32 s49, s48, 352
    s_sub_u32 s49, s55, s49
    s_add_u32 s48, s48, 8
    s_cmp_ge_u32 s49, 160
    s_cbranch_scc1 L_pf_v0
    s_mul_i32 s49, s49, 24576
    s_lshl_b32 s48, s48, 8
    s_add_u32 s48, s48, s49
    buffer_load_dwordx4 v[208:211], v137, s[36:39], s48 offen
    s_branch L_pf_n0
L_pf_v0:
    s_sub_u32 s49, s49, 160
    s_mul_i32 s50, s49, 171
    s_lshr_b32 s50, s50, 9
    s_mul_i32 s51, s50, 3
    s_sub_u32 s49, s49, s51
    s_lshl_b32 s48, s48, 6
    s_add_u32 s48, s48, s50
    s_mul_i32 s48, s48, 3072
    s_lshl_b32 s49, s49, 10
    s_add_u32 s48, s48, s49
    buffer_load_dwordx4 v[208:211], v136, s[40:43], s48 offen
L_pf_n0:
    s_add_u32 s55, s55, 128
    s_cmp_lt_u32 s55, 704
    s_cbranch_scc1 L_pfi_loop
    s_lshl_b32 s14, s13, 10
    s_add_u32 s14, s14, 1966080
    buffer_load_dwordx4 v[208:211], v136, s[40:43], s14 offen
    s_add_u32 s14, s14, 131072
    buffer_load_dwordx4 v[208:211], v136, s[40:43], s14 offen
    s_add_u32 s14, s14, 131072
    buffer_load_dwordx4 v[208:211], v136, s[40:43], s14 offen
    s_add_u32 s14, s14, 131072
    buffer_load_dwordx4 v[208:211], v136, s[40:43], s14 offen
    s_add_u32 s14, s14, 131072
    buffer_load_dwordx4 v[208:211], v136, s[40:43], s14 offen
    s_add_u32 s14, s14, 131072
    buffer_load_dwordx4 v[208:211], v136, s[40:43], s14 offen
    s_add_u32 s14, s14, 131072
    buffer_load_dwordx4 v[208:211], v136, s[40:43], s14 offen
    s_add_u32 s14, s14, 131072
    buffer_load_dwordx4 v[208:211], v136, s[40:43], s14 offen
    s_add_u32 s14, s14, 131072
    buffer_load_dwordx4 v[208:211], v136, s[40:43], s14 offen
    s_add_u32 s14, s14, 131072
    buffer_load_dwordx4 v[208:211], v136, s[40:43], s14 offen
    s_add_u32 s14, s14, 131072
    buffer_load_dwordx4 v[208:211], v136, s[40:43], s14 offen
    s_add_u32 s14, s14, 131072
    buffer_load_dwordx4 v[208:211], v136, s[40:43], s14 offen
    s_add_u32 s14, s14, 131072
    buffer_load_dwordx4 v[208:211], v136, s[40:43], s14 offen
    s_add_u32 s14, s14, 131072
    buffer_load_dwordx4 v[208:211], v136, s[40:43], s14 offen
    s_add_u32 s14, s14, 131072
    buffer_load_dwordx4 v[208:211], v136, s[40:43], s14 offen
    s_add_u32 s14, s14, 131072
    buffer_load_dwordx4 v[208:211], v136, s[40:43], s14 offen
    s_add_u32 s14, s14, 131072
    buffer_load_dwordx4 v[208:211], v136, s[40:43], s14 offen
    s_add_u32 s14, s14, 131072
    buffer_load_dwordx4 v[208:211], v136, s[40:43], s14 offen
    s_add_u32 s14, s14, 131072
    buffer_load_dwordx4 v[208:211], v136, s[40:43], s14 offen
    s_add_u32 s14, s14, 131072
    buffer_load_dwordx4 v[208:211], v136, s[40:43], s14 offen
    s_add_u32 s14, s14, 131072
    buffer_load_dwordx4 v[208:211], v136, s[40:43], s14 offen
    s_add_u32 s14, s14, 131072
    s_barrier
    s_cmp_lt_u32 s4, 4
    s_cbranch_scc1 L2_comp
    s_branch L2_load
L1b_pf:
    s_cmp_ge_u32 s4, 4
    s_cbranch_scc1 L1b_go
    s_mul_i32 s13, s5, 10
    s_add_u32 s13, s13, s6
    s_sub_u32 s13, s13, 20
    s_lshl_b32 s13, s13, 2
    s_add_u32 s13, s13, s4
    s_add_u32 s53, s13, 128
    s_mul_i32 s48, s13, 2979
    s_lshr_b32 s48, s48, 20
    s_mul_i32 s49, s48, 352
    s_sub_u32 s49, s13, s49
    s_add_u32 s48, s48, 1
    s_cmp_ge_u32 s49, 160
    s_cbranch_scc1 L_pf_v1
    s_mul_i32 s49, s49, 24576
    s_lshl_b32 s48, s48, 8
    s_add_u32 s48, s48, s49
    buffer_load_dwordx4 v[208:211], v137, s[36:39], s48 offen
    s_branch L_pf_n1
L_pf_v1:
    s_sub_u32 s49, s49, 160
    s_mul_i32 s50, s49, 171
    s_lshr_b32 s50, s50, 9
    s_mul_i32 s51, s50, 3
    s_sub_u32 s49, s49, s51
    s_lshl_b32 s48, s48, 6
    s_add_u32 s48, s48, s50
    s_mul_i32 s48, s48, 3072
    s_lshl_b32 s49, s49, 10
    s_add_u32 s48, s48, s49
    buffer_load_dwordx4 v[208:211], v136, s[40:43], s48 offen
L_pf_n1:
    s_add_u32 s13, s13, 320
    s_mul_i32 s48, s13, 2979
    s_lshr_b32 s48, s48, 20
    s_mul_i32 s49, s48, 352
    s_sub_u32 s49, s13, s49
    s_add_u32 s48, s48, 1
    s_cmp_ge_u32 s49, 160
    s_cbranch_scc1 L_pf_v2
    s_mul_i32 s49, s49, 24576
    s_lshl_b32 s48, s48, 8
    s_add_u32 s48, s48, s49
    buffer_load_dwordx4 v[208:211], v137, s[36:39], s48 offen
    s_branch L_pf_n2
L_pf_v2:
    s_sub_u32 s49, s49, 160
    s_mul_i32 s50, s49, 171
    s_lshr_b32 s50, s50, 9
    s_mul_i32 s51, s50, 3
    s_sub_u32 s49, s49, s51
    s_lshl_b32 s48, s48, 6
    s_add_u32 s48, s48, s50
    s_mul_i32 s48, s48, 3072
    s_lshl_b32 s49, s49, 10
    s_add_u32 s48, s48, s49
    buffer_load_dwordx4 v[208:211], v136, s[40:43], s48 offen
L_pf_n2:
    s_add_u32 s13, s13, 320
    s_mul_i32 s48, s13, 2979
    s_lshr_b32 s48, s48, 20
    s_mul_i32 s49, s48, 352
    s_sub_u32 s49, s13, s49
    s_add_u32 s48, s48, 1
    s_cmp_ge_u32 s49, 160
    s_cbranch_scc1 L_pf_v3
    s_mul_i32 s49, s49, 24576
    s_lshl_b32 s48, s48, 8
    s_add_u32 s48, s48, s49
    buffer_load_dwordx4 v[208:211], v137, s[36:39], s48 offen
    s_branch L_pf_n3
L_pf_v3:
    s_sub_u32 s49, s49, 160
    s_mul_i32 s50, s49, 171
    s_lshr_b32 s50, s50, 9
    s_mul_i32 s51, s50, 3
    s_sub_u32 s49, s49, s51
    s_lshl_b32 s48, s48, 6
    s_add_u32 s48, s48, s50
    s_mul_i32 s48, s48, 3072
    s_lshl_b32 s49, s49, 10
    s_add_u32 s48, s48, s49
    buffer_load_dwordx4 v[208:211], v136, s[40:43], s48 offen
L_pf_n3:
    s_add_u32 s13, s13, 320
    s_mov_b32 s44, s20
    s_and_b32 s45, s21, 0xffff
    s_mov_b32 s46, 3072
    s_mov_b32 s47, 0x00020000
    s_mov_b32 s55, s13
    s_mov_b32 s44, s20
    s_and_b32 s45, s21, 0xffff
    s_mov_b32 s46, 3072
    s_mov_b32 s47, 0x00020000
    s_mov_b32 s48, s22
    s_and_b32 s49, s23, 0xffff
    s_mov_b32 s50, 3072
    s_mov_b32 s51, 0x00020000
    v_lshrrev_b32 v2, 3, v0
    v_and_b32 v3, 7, v0
    v_mul_u32_u24 v4, 6144, v2
    v_lshl_add_u32 v4, v3, 5, v4
    v_add_u32 v5, 49152, v4
    v_lshlrev_b32 v6, 4, v3
    s_mul_i32 s15, s53, 1639
    s_lshr_b32 s15, s15, 16
    s_mul_i32 s34, s15, 40
    s_sub_u32 s34, s53, s34
    s_add_u32 s15, s15, 10
    s_lshr_b32 s68, s34, 2
    s_lshl_b32 s34, s34, 4
    s_mul_i32 s35, s34, 6144
    s_lshl_b32 s52, s15, 8
    s_add_u32 s35, s35, s52
    buffer_load_dwordx4 v[8:11], v4, s[36:39], s35 offen
    buffer_load_dwordx4 v[12:15], v4, s[36:39], s35 offen offset:16
    buffer_load_dwordx4 v[16:19], v5, s[36:39], s35 offen
    buffer_load_dwordx4 v[20:23], v5, s[36:39], s35 offen offset:16
    s_lshl_b32 s52, s15, 7
    buffer_load_dwordx4 v[24:27], v6, s[44:47], s52 offen
    buffer_load_dwordx4 v[28:31], v6, s[48:51], s52 offen
    s_mul_i32 s52, s68, 24
    s_add_u32 s52, s52, s15
    s_lshl_b32 s52, s52, 13
    s_and_b32 s34, s34, 63
    s_lshl_b32 s34, s34, 7
    s_add_u32 s64, s52, s34
    s_cmp_lt_u32 s15, 13
    s_cselect_b32 s72, 64, 128
    s_cmp_lt_u32 s15, 21
    s_cselect_b32 s72, s72, 192
    s_mov_b32 s13, s55
    s_mul_i32 s48, s13, 2979
    s_lshr_b32 s48, s48, 20
    s_mul_i32 s49, s48, 352
    s_sub_u32 s49, s13, s49
    s_add_u32 s48, s48, 1
    s_cmp_ge_u32 s49, 160
    s_cbranch_scc1 L_pf_v4
    s_mul_i32 s49, s49, 24576
    s_lshl_b32 s48, s48, 8
    s_add_u32 s48, s48, s49
    buffer_load_dwordx4 v[208:211], v137, s[36:39], s48 offen
    s_branch L_pf_n4
L_pf_v4:
    s_sub_u32 s49, s49, 160
    s_mul_i32 s50, s49, 171
    s_lshr_b32 s50, s50, 9
    s_mul_i32 s51, s50, 3
    s_sub_u32 s49, s49, s51
    s_lshl_b32 s48, s48, 6
    s_add_u32 s48, s48, s50
    s_mul_i32 s48, s48, 3072
    s_lshl_b32 s49, s49, 10
    s_add_u32 s48, s48, s49
    buffer_load_dwordx4 v[208:211], v136, s[40:43], s48 offen
L_pf_n4:
    s_add_u32 s13, s13, 320
    s_mul_i32 s48, s13, 2979
    s_lshr_b32 s48, s48, 20
    s_mul_i32 s49, s48, 352
    s_sub_u32 s49, s13, s49
    s_add_u32 s48, s48, 1
    s_cmp_ge_u32 s49, 160
    s_cbranch_scc1 L_pf_v5
    s_mul_i32 s49, s49, 24576
    s_lshl_b32 s48, s48, 8
    s_add_u32 s48, s48, s49
    buffer_load_dwordx4 v[208:211], v137, s[36:39], s48 offen
    s_branch L_pf_n5
L_pf_v5:
    s_sub_u32 s49, s49, 160
    s_mul_i32 s50, s49, 171
    s_lshr_b32 s50, s50, 9
    s_mul_i32 s51, s50, 3
    s_sub_u32 s49, s49, s51
    s_lshl_b32 s48, s48, 6
    s_add_u32 s48, s48, s50
    s_mul_i32 s48, s48, 3072
    s_lshl_b32 s49, s49, 10
    s_add_u32 s48, s48, s49
    buffer_load_dwordx4 v[208:211], v136, s[40:43], s48 offen
L_pf_n5:
    s_add_u32 s13, s13, 320
    s_mul_i32 s48, s13, 2979
    s_lshr_b32 s48, s48, 20
    s_mul_i32 s49, s48, 352
    s_sub_u32 s49, s13, s49
    s_add_u32 s48, s48, 1
    s_cmp_ge_u32 s49, 160
    s_cbranch_scc1 L_pf_v6
    s_mul_i32 s49, s49, 24576
    s_lshl_b32 s48, s48, 8
    s_add_u32 s48, s48, s49
    buffer_load_dwordx4 v[208:211], v137, s[36:39], s48 offen
    s_branch L_pf_n6
L_pf_v6:
    s_sub_u32 s49, s49, 160
    s_mul_i32 s50, s49, 171
    s_lshr_b32 s50, s50, 9
    s_mul_i32 s51, s50, 3
    s_sub_u32 s49, s49, s51
    s_lshl_b32 s48, s48, 6
    s_add_u32 s48, s48, s50
    s_mul_i32 s48, s48, 3072
    s_lshl_b32 s49, s49, 10
    s_add_u32 s48, s48, s49
    buffer_load_dwordx4 v[208:211], v136, s[40:43], s48 offen
L_pf_n6:
    s_add_u32 s13, s13, 320
    s_mul_i32 s48, s13, 2979
    s_lshr_b32 s48, s48, 20
    s_mul_i32 s49, s48, 352
    s_sub_u32 s49, s13, s49
    s_add_u32 s48, s48, 1
    s_cmp_ge_u32 s49, 160
    s_cbranch_scc1 L_pf_v7
    s_mul_i32 s49, s49, 24576
    s_lshl_b32 s48, s48, 8
    s_add_u32 s48, s48, s49
    buffer_load_dwordx4 v[208:211], v137, s[36:39], s48 offen
    s_branch L_pf_n7
L_pf_v7:
    s_sub_u32 s49, s49, 160
    s_mul_i32 s50, s49, 171
    s_lshr_b32 s50, s50, 9
    s_mul_i32 s51, s50, 3
    s_sub_u32 s49, s49, s51
    s_lshl_b32 s48, s48, 6
    s_add_u32 s48, s48, s50
    s_mul_i32 s48, s48, 3072
    s_lshl_b32 s49, s49, 10
    s_add_u32 s48, s48, s49
    buffer_load_dwordx4 v[208:211], v136, s[40:43], s48 offen
L_pf_n7:
    s_add_u32 s13, s13, 320
    s_mul_i32 s48, s13, 2979
    s_lshr_b32 s48, s48, 20
    s_mul_i32 s49, s48, 352
    s_sub_u32 s49, s13, s49
    s_add_u32 s48, s48, 1
    s_cmp_ge_u32 s49, 160
    s_cbranch_scc1 L_pf_v8
    s_mul_i32 s49, s49, 24576
    s_lshl_b32 s48, s48, 8
    s_add_u32 s48, s48, s49
    buffer_load_dwordx4 v[208:211], v137, s[36:39], s48 offen
    s_branch L_pf_n8
L_pf_v8:
    s_sub_u32 s49, s49, 160
    s_mul_i32 s50, s49, 171
    s_lshr_b32 s50, s50, 9
    s_mul_i32 s51, s50, 3
    s_sub_u32 s49, s49, s51
    s_lshl_b32 s48, s48, 6
    s_add_u32 s48, s48, s50
    s_mul_i32 s48, s48, 3072
    s_lshl_b32 s49, s49, 10
    s_add_u32 s48, s48, s49
    buffer_load_dwordx4 v[208:211], v136, s[40:43], s48 offen
L_pf_n8:
    s_add_u32 s13, s13, 320
    v_lshrrev_b32 v7, 4, v0
    v_xor_b32 v7, v3, v7
    v_xor_b32 v3, 4, v7
    v_lshlrev_b32 v2, 7, v2
    v_lshl_add_u32 v3, v3, 4, v2
    v_add_u32 v3, 1024, v3
    v_lshl_add_u32 v2, v7, 4, v2
    s_add_u32 s44, s32, 7340032
    s_addc_u32 s45, s33, 0
    s_and_b32 s45, s45, 0xffff
    s_mov_b32 s46, 1966080
    s_mov_b32 s47, 0x00020000
    v_lshlrev_b32 v128, 2, v0
    v_mov_b32 v129, 1
    s_waitcnt vmcnt(5)
    v_lshlrev_b32 v112, 16, v24
    v_and_b32 v113, 0xffff0000, v24
    v_lshlrev_b32 v120, 16, v28
    v_and_b32 v121, 0xffff0000, v28
    v_lshlrev_b32 v114, 16, v25
    v_and_b32 v115, 0xffff0000, v25
    v_lshlrev_b32 v122, 16, v29
    v_and_b32 v123, 0xffff0000, v29
    v_lshlrev_b32 v116, 16, v26
    v_and_b32 v117, 0xffff0000, v26
    v_lshlrev_b32 v124, 16, v30
    v_and_b32 v125, 0xffff0000, v30
    v_lshlrev_b32 v118, 16, v27
    v_and_b32 v119, 0xffff0000, v27
    v_lshlrev_b32 v126, 16, v31
    v_and_b32 v127, 0xffff0000, v31
    v_mul_f32 v120, -v120, v112
    v_mul_f32 v121, -v121, v113
    v_mul_f32 v122, -v122, v114
    v_mul_f32 v123, -v123, v115
    v_mul_f32 v124, -v124, v116
    v_mul_f32 v125, -v125, v117
    v_mul_f32 v126, -v126, v118
    v_mul_f32 v127, -v127, v119
    v_cvt_f32_i32 v8, v8
    v_cvt_f32_i32 v9, v9
    v_cvt_f32_i32 v10, v10
    v_cvt_f32_i32 v11, v11
    v_cvt_f32_i32 v12, v12
    v_cvt_f32_i32 v13, v13
    v_cvt_f32_i32 v14, v14
    v_cvt_f32_i32 v15, v15
    v_fma_f32 v8, v8, v112, v120
    v_fma_f32 v9, v9, v113, v121
    v_fma_f32 v10, v10, v114, v122
    v_fma_f32 v11, v11, v115, v123
    v_fma_f32 v12, v12, v116, v124
    v_fma_f32 v13, v13, v117, v125
    v_fma_f32 v14, v14, v118, v126
    v_fma_f32 v15, v15, v119, v127
    v_cvt_pk_bf16_f32 v8, v8, v9
    v_cvt_pk_bf16_f32 v9, v10, v11
    v_cvt_pk_bf16_f32 v10, v12, v13
    v_cvt_pk_bf16_f32 v11, v14, v15
    buffer_store_dwordx4 v[8:11], v2, s[44:47], s64 offen sc1
    v_cvt_f32_i32 v16, v16
    v_cvt_f32_i32 v17, v17
    v_cvt_f32_i32 v18, v18
    v_cvt_f32_i32 v19, v19
    v_cvt_f32_i32 v20, v20
    v_cvt_f32_i32 v21, v21
    v_cvt_f32_i32 v22, v22
    v_cvt_f32_i32 v23, v23
    v_fma_f32 v16, v16, v112, v120
    v_fma_f32 v17, v17, v113, v121
    v_fma_f32 v18, v18, v114, v122
    v_fma_f32 v19, v19, v115, v123
    v_fma_f32 v20, v20, v116, v124
    v_fma_f32 v21, v21, v117, v125
    v_fma_f32 v22, v22, v118, v126
    v_fma_f32 v23, v23, v119, v127
    v_cvt_pk_bf16_f32 v16, v16, v17
    v_cvt_pk_bf16_f32 v17, v18, v19
    v_cvt_pk_bf16_f32 v18, v20, v21
    v_cvt_pk_bf16_f32 v19, v22, v23
    buffer_store_dwordx4 v[16:19], v3, s[44:47], s64 offen sc1
L1b_go:
    s_sub_u32 s9, s6, 20
    s_and_b32 s7, s9, 1
    s_lshl_b32 s8, s5, 1
    s_add_u32 s7, s7, s8
    s_lshr_b32 s8, s9, 1
    s_cmp_lt_u32 s4, 4
    s_cbranch_scc1 L1b_cons
    s_sub_u32 s11, s4, 4
    v_lshrrev_b32 v16, 3, v0
    v_and_b32 v17, 7, v0
    v_lshrrev_b32 v18, 4, v0
    s_lshl_b32 s12, s7, 7
    s_lshl_b32 s13, s11, 5
    s_add_u32 s12, s12, s13
    v_add_u32 v16, s12, v16
    v_mul_u32_u24 v16, 1280, v16
    v_xor_b32 v19, v17, v18
    v_xor_b32 v18, 4, v19
    v_lshl_add_u32 v20, v19, 4, v16
    v_lshl_add_u32 v21, v18, 4, v16
    v_add_u32 v21, 10240, v21
    v_add_u32 v22, 20480, v20
    v_add_u32 v23, 20480, v21
    v_lshrrev_b32 v16, 4, v0
    v_bfe_u32 v17, v0, 2, 2
    v_xor_b32 v17, v17, v16
    v_and_b32 v18, 3, v0
    s_lshl_b32 s12, s11, 4
    v_add_u32 v16, s12, v16
    v_mul_u32_u24 v16, 1280, v16
    v_lshl_add_u32 v16, v17, 6, v16
    v_lshl_add_u32 v16, v18, 4, v16
    s_lshl_b32 s12, s8, 8
    v_add_u32 v24, s12, v16
    v_add_u32 v25, 5120, v24
    v_add_u32 v26, 10240, v24
    v_add_u32 v27, 15360, v24
    s_lshl_b32 s12, s11, 12
    s_mov_b32 s13, 0
    s_mov_b32 s14, 0
    s_mov_b32 s15, 0
    s_mov_b32 s36, s16
    s_and_b32 s37, s17, 0xffff
    s_mov_b32 s38, 2621440
    s_mov_b32 s39, 0x00020000
    s_mov_b32 s40, s24
    s_and_b32 s41, s25, 0xffff
    s_mov_b32 s42, 819200
    s_mov_b32 s43, 0x00020000
    s_add_u32 s34, s15, s12
    s_add_u32 m0, s34, 0
    s_nop 0
    buffer_load_dwordx4 v20, s[36:39], s13 offen lds
    s_add_u32 m0, s34, 1024
    s_nop 0
    buffer_load_dwordx4 v21, s[36:39], s13 offen lds
    s_add_u32 m0, s34, 2048
    s_nop 0
    buffer_load_dwordx4 v22, s[36:39], s13 offen lds
    s_add_u32 m0, s34, 3072
    s_nop 0
    buffer_load_dwordx4 v23, s[36:39], s13 offen lds
    s_add_u32 m0, s34, 16384
    s_nop 0
    buffer_load_dwordx4 v24, s[40:43], s14 offen lds
    s_add_u32 m0, s34, 17408
    s_nop 0
    buffer_load_dwordx4 v25, s[40:43], s14 offen lds
    s_add_u32 m0, s34, 18432
    s_nop 0
    buffer_load_dwordx4 v26, s[40:43], s14 offen lds
    s_add_u32 m0, s34, 19456
    s_nop 0
    buffer_load_dwordx4 v27, s[40:43], s14 offen lds
    s_add_u32 s13, s13, 128
    s_add_u32 s14, s14, 81920
    s_add_u32 s15, s15, 32768
    s_and_b32 s15, s15, 131071
    s_add_u32 s34, s15, s12
    s_add_u32 m0, s34, 0
    s_nop 0
    buffer_load_dwordx4 v20, s[36:39], s13 offen lds
    s_add_u32 m0, s34, 1024
    s_nop 0
    buffer_load_dwordx4 v21, s[36:39], s13 offen lds
    s_add_u32 m0, s34, 2048
    s_nop 0
    buffer_load_dwordx4 v22, s[36:39], s13 offen lds
    s_add_u32 m0, s34, 3072
    s_nop 0
    buffer_load_dwordx4 v23, s[36:39], s13 offen lds
    s_add_u32 m0, s34, 16384
    s_nop 0
    buffer_load_dwordx4 v24, s[40:43], s14 offen lds
    s_add_u32 m0, s34, 17408
    s_nop 0
    buffer_load_dwordx4 v25, s[40:43], s14 offen lds
    s_add_u32 m0, s34, 18432
    s_nop 0
    buffer_load_dwordx4 v26, s[40:43], s14 offen lds
    s_add_u32 m0, s34, 19456
    s_nop 0
    buffer_load_dwordx4 v27, s[40:43], s14 offen lds
    s_add_u32 s13, s13, 128
    s_add_u32 s14, s14, 81920
    s_add_u32 s15, s15, 32768
    s_and_b32 s15, s15, 131071
    s_mov_b32 s35, 0
L1b_ploop:
    s_add_u32 s34, s15, s12
    s_add_u32 m0, s34, 0
    s_nop 0
    buffer_load_dwordx4 v20, s[36:39], s13 offen lds
    s_add_u32 m0, s34, 1024
    s_nop 0
    buffer_load_dwordx4 v21, s[36:39], s13 offen lds
    s_add_u32 m0, s34, 2048
    s_nop 0
    buffer_load_dwordx4 v22, s[36:39], s13 offen lds
    s_add_u32 m0, s34, 3072
    s_nop 0
    buffer_load_dwordx4 v23, s[36:39], s13 offen lds
    s_add_u32 m0, s34, 16384
    s_nop 0
    buffer_load_dwordx4 v24, s[40:43], s14 offen lds
    s_add_u32 m0, s34, 17408
    s_nop 0
    buffer_load_dwordx4 v25, s[40:43], s14 offen lds
    s_add_u32 m0, s34, 18432
    s_nop 0
    buffer_load_dwordx4 v26, s[40:43], s14 offen lds
    s_add_u32 m0, s34, 19456
    s_nop 0
    buffer_load_dwordx4 v27, s[40:43], s14 offen lds
    s_add_u32 s13, s13, 128
    s_add_u32 s14, s14, 81920
    s_add_u32 s15, s15, 32768
    s_and_b32 s15, s15, 131071
    s_waitcnt vmcnt(16)
    s_barrier
    s_add_u32 s35, s35, 1
    s_cmp_lt_u32 s35, 8
    s_cbranch_scc1 L1b_ploop
    s_waitcnt vmcnt(8)
    s_barrier
    s_waitcnt vmcnt(0)
    s_barrier
    s_barrier
    s_branch L2_load
L1b_cons:
    s_and_b32 s11, s4, 1
    s_lshr_b32 s12, s4, 1
    v_and_b32 v16, 31, v0
    v_lshrrev_b32 v17, 5, v0
    v_bfe_u32 v18, v16, 1, 3
    v_xor_b32 v18, v17, v18
    s_lshl_b32 s13, s11, 13
    v_lshl_add_u32 v19, v16, 7, s13
    v_xor_b32 v14, 0, v18
    v_lshl_add_u32 v2, v14, 4, v19
    v_xor_b32 v14, 2, v18
    v_lshl_add_u32 v3, v14, 4, v19
    v_xor_b32 v14, 4, v18
    v_lshl_add_u32 v4, v14, 4, v19
    v_xor_b32 v14, 6, v18
    v_lshl_add_u32 v5, v14, 4, v19
    v_bfe_u32 v18, v0, 2, 2
    v_and_b32 v19, 3, v0
    v_bfe_u32 v14, v0, 4, 1
    v_lshl_add_u32 v15, v17, 3, v18
    v_lshlrev_b32 v15, 8, v15
    v_lshl_add_u32 v15, v14, 5, v15
    v_lshl_add_u32 v15, v19, 3, v15
    v_add_u32 v15, 16384, v15
    s_lshl_b32 s13, s12, 1
    s_add_u32 s14, s13, 0
    v_xor_b32 v14, s14, v18
    v_lshl_add_u32 v6, v14, 6, v15
    s_add_u32 s14, s13, 1
    v_xor_b32 v14, s14, v18
    v_lshl_add_u32 v7, v14, 6, v15
    v_mov_b32 v16, 0
    v_mov_b32 v17, 0
    v_mov_b32 v18, 0
    v_mov_b32 v19, 0
    v_mov_b32 v20, 0
    v_mov_b32 v21, 0
    v_mov_b32 v22, 0
    v_mov_b32 v23, 0
    v_mov_b32 v24, 0
    v_mov_b32 v25, 0
    v_mov_b32 v26, 0
    v_mov_b32 v27, 0
    v_mov_b32 v28, 0
    v_mov_b32 v29, 0
    v_mov_b32 v30, 0
    v_mov_b32 v31, 0
    v_mov_b32 v32, 0
    v_mov_b32 v33, 0
    v_mov_b32 v34, 0
    v_mov_b32 v35, 0
    v_mov_b32 v36, 0
    v_mov_b32 v37, 0
    v_mov_b32 v38, 0
    v_mov_b32 v39, 0
    v_mov_b32 v40, 0
    v_mov_b32 v41, 0
    v_mov_b32 v42, 0
    v_mov_b32 v43, 0
    v_mov_b32 v44, 0
    v_mov_b32 v45, 0
    v_mov_b32 v46, 0
    v_mov_b32 v47, 0
    v_mov_b32 v48, 0
    v_mov_b32 v49, 0
    v_mov_b32 v50, 0
    v_mov_b32 v51, 0
    v_mov_b32 v52, 0
    v_mov_b32 v53, 0
    v_mov_b32 v54, 0
    v_mov_b32 v55, 0
    v_mov_b32 v56, 0
    v_mov_b32 v57, 0
    v_mov_b32 v58, 0
    v_mov_b32 v59, 0
    v_mov_b32 v60, 0
    v_mov_b32 v61, 0
    v_mov_b32 v62, 0
    v_mov_b32 v63, 0
    v_mov_b32 v64, 0
    v_mov_b32 v65, 0
    v_mov_b32 v66, 0
    v_mov_b32 v67, 0
    v_mov_b32 v68, 0
    v_mov_b32 v69, 0
    v_mov_b32 v70, 0
    v_mov_b32 v71, 0
    v_mov_b32 v72, 0
    v_mov_b32 v73, 0
    v_mov_b32 v74, 0
    v_mov_b32 v75, 0
    v_mov_b32 v76, 0
    v_mov_b32 v77, 0
    v_mov_b32 v78, 0
    v_mov_b32 v79, 0
    v_mov_b32 v144, 0
    v_mov_b32 v145, 0
    v_mov_b32 v146, 0
    v_mov_b32 v147, 0
    v_mov_b32 v148, 0
    v_mov_b32 v149, 0
    v_mov_b32 v150, 0
    v_mov_b32 v151, 0
    v_mov_b32 v152, 0
    v_mov_b32 v153, 0
    v_mov_b32 v154, 0
    v_mov_b32 v155, 0
    v_mov_b32 v156, 0
    v_mov_b32 v157, 0
    v_mov_b32 v158, 0
    v_mov_b32 v159, 0
    v_mov_b32 v160, 0
    v_mov_b32 v161, 0
    v_mov_b32 v162, 0
    v_mov_b32 v163, 0
    v_mov_b32 v164, 0
    v_mov_b32 v165, 0
    v_mov_b32 v166, 0
    v_mov_b32 v167, 0
    v_mov_b32 v168, 0
    v_mov_b32 v169, 0
    v_mov_b32 v170, 0
    v_mov_b32 v171, 0
    v_mov_b32 v172, 0
    v_mov_b32 v173, 0
    v_mov_b32 v174, 0
    v_mov_b32 v175, 0
    v_mov_b32 v176, 0
    v_mov_b32 v177, 0
    v_mov_b32 v178, 0
    v_mov_b32 v179, 0
    v_mov_b32 v180, 0
    v_mov_b32 v181, 0
    v_mov_b32 v182, 0
    v_mov_b32 v183, 0
    v_mov_b32 v184, 0
    v_mov_b32 v185, 0
    v_mov_b32 v186, 0
    v_mov_b32 v187, 0
    v_mov_b32 v188, 0
    v_mov_b32 v189, 0
    v_mov_b32 v190, 0
    v_mov_b32 v191, 0
    v_mov_b32 v192, 0
    v_mov_b32 v193, 0
    v_mov_b32 v194, 0
    v_mov_b32 v195, 0
    v_mov_b32 v196, 0
    v_mov_b32 v197, 0
    v_mov_b32 v198, 0
    v_mov_b32 v199, 0
    v_mov_b32 v200, 0
    v_mov_b32 v201, 0
    v_mov_b32 v202, 0
    v_mov_b32 v203, 0
    v_mov_b32 v204, 0
    v_mov_b32 v205, 0
    v_mov_b32 v206, 0
    v_mov_b32 v207, 0
    s_mov_b32 s44, s32
    s_and_b32 s45, s33, 0xffff
    s_mov_b32 s46, 2621440
    s_mov_b32 s47, 0x00020000
    s_mov_b32 s14, 0
    s_mov_b32 s15, 0
L1b_cloop:
    s_barrier
    v_add_u32 v8, s14, v2
    v_add_u32 v9, s14, v3
    v_add_u32 v10, s14, v4
    v_add_u32 v11, s14, v5
    v_add_u32 v12, s14, v6
    v_add_u32 v13, s14, v7
    s_add_u32 s14, s14, 32768
    s_and_b32 s14, s14, 131071
    ds_read_b128 v[80:83], v8 offset:0
    ds_read_b128 v[84:87], v8 offset:4096
    v_mfma_f32_32x32x16_bf16 v[16:31], v[152:155], v[144:147], v[16:31]
    ds_read_b64_tr_b16 v[88:89], v12 offset:0
    ds_read_b64_tr_b16 v[90:91], v12 offset:1024
    v_mfma_f32_32x32x16_bf16 v[32:47], v[152:155], v[148:151], v[32:47]
    ds_read_b64_tr_b16 v[92:93], v13 offset:0
    ds_read_b64_tr_b16 v[94:95], v13 offset:1024
    v_mfma_f32_32x32x16_bf16 v[48:63], v[156:159], v[144:147], v[48:63]
    ds_read_b128 v[96:99], v9 offset:0
    ds_read_b128 v[100:103], v9 offset:4096
    v_mfma_f32_32x32x16_bf16 v[64:79], v[156:159], v[148:151], v[64:79]
    ds_read_b64_tr_b16 v[104:105], v12 offset:4096
    ds_read_b64_tr_b16 v[106:107], v12 offset:5120
    v_mfma_f32_32x32x16_bf16 v[16:31], v[168:171], v[160:163], v[16:31]
    ds_read_b64_tr_b16 v[108:109], v13 offset:4096
    ds_read_b64_tr_b16 v[110:111], v13 offset:5120
    v_mfma_f32_32x32x16_bf16 v[32:47], v[168:171], v[164:167], v[32:47]
    ds_read_b128 v[112:115], v10 offset:0
    ds_read_b128 v[116:119], v10 offset:4096
    v_mfma_f32_32x32x16_bf16 v[48:63], v[172:175], v[160:163], v[48:63]
    ds_read_b64_tr_b16 v[120:121], v12 offset:8192
    ds_read_b64_tr_b16 v[122:123], v12 offset:9216
    v_mfma_f32_32x32x16_bf16 v[64:79], v[172:175], v[164:167], v[64:79]
    ds_read_b64_tr_b16 v[124:125], v13 offset:8192
    ds_read_b64_tr_b16 v[126:127], v13 offset:9216
    v_mfma_f32_32x32x16_bf16 v[16:31], v[184:187], v[176:179], v[16:31]
    ds_read_b128 v[128:131], v11 offset:0
    ds_read_b128 v[132:135], v11 offset:4096
    v_mfma_f32_32x32x16_bf16 v[32:47], v[184:187], v[180:183], v[32:47]
    ds_read_b64_tr_b16 v[136:137], v12 offset:12288
    ds_read_b64_tr_b16 v[138:139], v12 offset:13312
    v_mfma_f32_32x32x16_bf16 v[48:63], v[188:191], v[176:179], v[48:63]
    ds_read_b64_tr_b16 v[140:141], v13 offset:12288
    ds_read_b64_tr_b16 v[142:143], v13 offset:13312
    v_mfma_f32_32x32x16_bf16 v[64:79], v[188:191], v[180:183], v[64:79]
    v_mfma_f32_32x32x16_bf16 v[16:31], v[200:203], v[192:195], v[16:31]
    v_mfma_f32_32x32x16_bf16 v[32:47], v[200:203], v[196:199], v[32:47]
    v_mfma_f32_32x32x16_bf16 v[48:63], v[204:207], v[192:195], v[48:63]
    v_mfma_f32_32x32x16_bf16 v[64:79], v[204:207], v[196:199], v[64:79]
    s_waitcnt vmcnt(0)
    s_waitcnt lgkmcnt(0)
    s_barrier
    v_add_u32 v8, s14, v2
    v_add_u32 v9, s14, v3
    v_add_u32 v10, s14, v4
    v_add_u32 v11, s14, v5
    v_add_u32 v12, s14, v6
    v_add_u32 v13, s14, v7
    s_add_u32 s14, s14, 32768
    s_and_b32 s14, s14, 131071
    ds_read_b128 v[144:147], v8 offset:0
    ds_read_b128 v[148:151], v8 offset:4096
    v_mfma_f32_32x32x16_bf16 v[16:31], v[88:91], v[80:83], v[16:31]
    ds_read_b64_tr_b16 v[152:153], v12 offset:0
    ds_read_b64_tr_b16 v[154:155], v12 offset:1024
    v_mfma_f32_32x32x16_bf16 v[32:47], v[88:91], v[84:87], v[32:47]
    ds_read_b64_tr_b16 v[156:157], v13 offset:0
    ds_read_b64_tr_b16 v[158:159], v13 offset:1024
    v_mfma_f32_32x32x16_bf16 v[48:63], v[92:95], v[80:83], v[48:63]
    ds_read_b128 v[160:163], v9 offset:0
    ds_read_b128 v[164:167], v9 offset:4096
    v_mfma_f32_32x32x16_bf16 v[64:79], v[92:95], v[84:87], v[64:79]
    ds_read_b64_tr_b16 v[168:169], v12 offset:4096
    ds_read_b64_tr_b16 v[170:171], v12 offset:5120
    v_mfma_f32_32x32x16_bf16 v[16:31], v[104:107], v[96:99], v[16:31]
    ds_read_b64_tr_b16 v[172:173], v13 offset:4096
    ds_read_b64_tr_b16 v[174:175], v13 offset:5120
    v_mfma_f32_32x32x16_bf16 v[32:47], v[104:107], v[100:103], v[32:47]
    ds_read_b128 v[176:179], v10 offset:0
    ds_read_b128 v[180:183], v10 offset:4096
    v_mfma_f32_32x32x16_bf16 v[48:63], v[108:111], v[96:99], v[48:63]
    ds_read_b64_tr_b16 v[184:185], v12 offset:8192
    ds_read_b64_tr_b16 v[186:187], v12 offset:9216
    v_mfma_f32_32x32x16_bf16 v[64:79], v[108:111], v[100:103], v[64:79]
    ds_read_b64_tr_b16 v[188:189], v13 offset:8192
    ds_read_b64_tr_b16 v[190:191], v13 offset:9216
    v_mfma_f32_32x32x16_bf16 v[16:31], v[120:123], v[112:115], v[16:31]
    ds_read_b128 v[192:195], v11 offset:0
    ds_read_b128 v[196:199], v11 offset:4096
    v_mfma_f32_32x32x16_bf16 v[32:47], v[120:123], v[116:119], v[32:47]
    ds_read_b64_tr_b16 v[200:201], v12 offset:12288
    ds_read_b64_tr_b16 v[202:203], v12 offset:13312
    v_mfma_f32_32x32x16_bf16 v[48:63], v[124:127], v[112:115], v[48:63]
    ds_read_b64_tr_b16 v[204:205], v13 offset:12288
    ds_read_b64_tr_b16 v[206:207], v13 offset:13312
    v_mfma_f32_32x32x16_bf16 v[64:79], v[124:127], v[116:119], v[64:79]
    v_mfma_f32_32x32x16_bf16 v[16:31], v[136:139], v[128:131], v[16:31]
    v_mfma_f32_32x32x16_bf16 v[32:47], v[136:139], v[132:135], v[32:47]
    v_mfma_f32_32x32x16_bf16 v[48:63], v[140:143], v[128:131], v[48:63]
    v_mfma_f32_32x32x16_bf16 v[64:79], v[140:143], v[132:135], v[64:79]
    s_or_b32 s13, s15, s4
    s_cmp_lg_u32 s13, 0
    s_cbranch_scc1 L1b_nhs
    s_mov_b32 s76, s14
    v_mov_b32 v212, 0
    v_mov_b32 v213, 1
    s_mov_b32 s48, s30
    s_and_b32 s49, s31, 0xffff
    s_mov_b32 s50, 256
    s_mov_b32 s51, 0x00020000
    s_lshl_b32 s14, s68, 2
    s_add_u32 s14, s14, s72
    s_mov_b64 exec, 1
    buffer_atomic_add v213, v212, s[48:51], s14 offen sc1
    s_mov_b64 exec, -1
    s_mov_b32 s14, s76
L1b_nhs:
    s_waitcnt lgkmcnt(0)
    s_add_u32 s15, s15, 1
    s_cmp_lt_u32 s15, 5
    s_cbranch_scc1 L1b_cloop
    s_mov_b32 s48, s30
    s_and_b32 s49, s31, 0xffff
    s_mov_b32 s50, 256
    s_mov_b32 s51, 0x00020000
    v_mov_b32 v2, 0
    buffer_load_dword v5, v2, s[48:51], 0 offen sc1
    s_barrier
    v_mfma_f32_32x32x16_bf16 v[16:31], v[152:155], v[144:147], v[16:31]
    v_mfma_f32_32x32x16_bf16 v[32:47], v[152:155], v[148:151], v[32:47]
    v_mfma_f32_32x32x16_bf16 v[48:63], v[156:159], v[144:147], v[48:63]
    v_mfma_f32_32x32x16_bf16 v[64:79], v[156:159], v[148:151], v[64:79]
    v_mfma_f32_32x32x16_bf16 v[16:31], v[168:171], v[160:163], v[16:31]
    v_mfma_f32_32x32x16_bf16 v[32:47], v[168:171], v[164:167], v[32:47]
    v_mfma_f32_32x32x16_bf16 v[48:63], v[172:175], v[160:163], v[48:63]
    v_mfma_f32_32x32x16_bf16 v[64:79], v[172:175], v[164:167], v[64:79]
    v_mfma_f32_32x32x16_bf16 v[16:31], v[184:187], v[176:179], v[16:31]
    v_mfma_f32_32x32x16_bf16 v[32:47], v[184:187], v[180:183], v[32:47]
    v_mfma_f32_32x32x16_bf16 v[48:63], v[188:191], v[176:179], v[48:63]
    v_mfma_f32_32x32x16_bf16 v[64:79], v[188:191], v[180:183], v[64:79]
    v_mfma_f32_32x32x16_bf16 v[16:31], v[200:203], v[192:195], v[16:31]
    v_mfma_f32_32x32x16_bf16 v[32:47], v[200:203], v[196:199], v[32:47]
    v_mfma_f32_32x32x16_bf16 v[48:63], v[204:207], v[192:195], v[48:63]
    v_mfma_f32_32x32x16_bf16 v[64:79], v[204:207], v[196:199], v[64:79]
    v_lshlrev_b32 v1, 4, v0
    s_lshl_b32 s13, s7, 2
    s_lshl_b32 s14, s11, 1
    s_add_u32 s13, s13, s14
    s_mul_i32 s13, s13, 20
    s_lshl_b32 s14, s8, 2
    s_add_u32 s13, s13, s14
    s_lshl_b32 s14, s12, 1
    s_add_u32 s13, s13, s14
    s_lshl_b32 s13, s13, 11
    s_add_u32 s14, s13, 40960
    s_nop 3
    v_cvt_pk_bf16_f32 v80, v16, v17
    v_cvt_pk_bf16_f32 v81, v18, v19
    v_cvt_pk_bf16_f32 v82, v20, v21
    v_cvt_pk_bf16_f32 v83, v22, v23
    buffer_store_dwordx4 v[80:83], v1, s[44:47], s13 offen offset:0 sc1
    v_cvt_pk_bf16_f32 v84, v24, v25
    v_cvt_pk_bf16_f32 v85, v26, v27
    v_cvt_pk_bf16_f32 v86, v28, v29
    v_cvt_pk_bf16_f32 v87, v30, v31
    buffer_store_dwordx4 v[84:87], v1, s[44:47], s13 offen offset:1024 sc1
    v_cvt_pk_bf16_f32 v88, v32, v33
    v_cvt_pk_bf16_f32 v89, v34, v35
    v_cvt_pk_bf16_f32 v90, v36, v37
    v_cvt_pk_bf16_f32 v91, v38, v39
    buffer_store_dwordx4 v[88:91], v1, s[44:47], s14 offen offset:0 sc1
    v_cvt_pk_bf16_f32 v92, v40, v41
    v_cvt_pk_bf16_f32 v93, v42, v43
    v_cvt_pk_bf16_f32 v94, v44, v45
    v_cvt_pk_bf16_f32 v95, v46, v47
    buffer_store_dwordx4 v[92:95], v1, s[44:47], s14 offen offset:1024 sc1
    v_cvt_pk_bf16_f32 v96, v48, v49
    v_cvt_pk_bf16_f32 v97, v50, v51
    v_cvt_pk_bf16_f32 v98, v52, v53
    v_cvt_pk_bf16_f32 v99, v54, v55
    buffer_store_dwordx4 v[96:99], v1, s[44:47], s13 offen offset:2048 sc1
    v_cvt_pk_bf16_f32 v100, v56, v57
    v_cvt_pk_bf16_f32 v101, v58, v59
    v_cvt_pk_bf16_f32 v102, v60, v61
    v_cvt_pk_bf16_f32 v103, v62, v63
    buffer_store_dwordx4 v[100:103], v1, s[44:47], s13 offen offset:3072 sc1
    v_cvt_pk_bf16_f32 v104, v64, v65
    v_cvt_pk_bf16_f32 v105, v66, v67
    v_cvt_pk_bf16_f32 v106, v68, v69
    v_cvt_pk_bf16_f32 v107, v70, v71
    buffer_store_dwordx4 v[104:107], v1, s[44:47], s14 offen offset:2048 sc1
    v_cvt_pk_bf16_f32 v108, v72, v73
    v_cvt_pk_bf16_f32 v109, v74, v75
    v_cvt_pk_bf16_f32 v110, v76, v77
    v_cvt_pk_bf16_f32 v111, v78, v79
    buffer_store_dwordx4 v[108:111], v1, s[44:47], s14 offen offset:3072 sc1
    v_mov_b32 v3, 1
    v_mov_b32 v2, 131072
    s_waitcnt vmcnt(0)
    s_mov_b64 exec, 1
    ds_add_rtn_u32 v4, v2, v3
    s_mov_b64 exec, -1
    s_waitcnt lgkmcnt(0)
    v_readfirstlane_b32 s14, v4
    s_cmp_lg_u32 s14, 3
    s_cbranch_scc1 Lsig_x_done
    v_readfirstlane_b32 s14, v5
    v_mov_b32 v2, 0
    s_cmp_ge_u32 s14, 96
    s_cbranch_scc1 Lsig_x_init_ok
    s_mov_b32 s15, 0
Lsig_x_init:
    buffer_load_dword v4, v2, s[48:51], 0 offen sc1
    s_waitcnt vmcnt(0)
    v_readfirstlane_b32 s14, v4
    s_add_u32 s15, s15, 1
    s_cmp_ge_u32 s14, 96
    s_cbranch_scc1 Lsig_x_init_ok
    s_sleep 8
    s_cmp_lt_u32 s15, 0x40000
    s_cbranch_scc1 Lsig_x_init
Lsig_x_init_ok:
    s_add_u32 s48, s32, 6291456
    s_addc_u32 s49, s33, 0
    s_and_b32 s49, s49, 0xffff
    s_mov_b32 s50, 32768
    s_mov_b32 s51, 0x00020000
    v_lshrrev_b32 v2, 3, v0
    v_and_b32 v4, 7, v0
    s_lshr_b32 s14, s7, 2
    s_lshl_b32 s14, s14, 1
    s_and_b32 s15, s7, 3
    s_lshl_b32 s15, s15, 3
    s_add_u32 s14, s14, s15
    v_lshl_add_u32 v2, v4, 5, v2
    v_add_u32 v2, s14, v2
    v_lshlrev_b32 v2, 7, v2
    s_mov_b64 exec, 0xffff
    buffer_atomic_add v3, v2, s[48:51], 0 offen offset:0 sc1
    s_mov_b64 exec, -1
Lsig_x_done:
L2_comp:
    s_lshr_b32 s7, s5, 1
    s_lshl_b32 s7, s7, 2
    s_and_b32 s8, s6, 3
    s_add_u32 s7, s7, s8
    s_and_b32 s8, s5, 1
    s_lshl_b32 s8, s8, 3
    s_lshr_b32 s9, s6, 2
    s_add_u32 s8, s8, s9
    v_lshlrev_b32 v1, 4, v0
    v_mov_b32 v3, 0
    s_add_u32 s48, s32, 6291456
    s_addc_u32 s49, s33, 0
    s_and_b32 s49, s49, 0xffff
    s_mov_b32 s50, 32768
    s_mov_b32 s51, 0x00020000
    s_lshl_b32 s13, s2, 7
    v_add_u32 v2, 0x10000, v1
    s_mov_b32 s36, s32
    s_and_b32 s37, s33, 0xffff
    s_mov_b32 s38, 2621440
    s_mov_b32 s39, 0x00020000
    s_mov_b32 s44, s28
    s_and_b32 s45, s29, 0xffff
    s_mov_b32 s46, 6291456
    s_mov_b32 s47, 0x00020000
    s_lshl_b32 s9, s7, 2
    s_add_u32 s9, s9, s4
    s_mul_i32 s10, s9, 40960
    s_cmp_lg_u32 s4, 0
    s_cbranch_scc1 L2_xwait
    s_cmp_lg_u32 s78, 0
    s_cbranch_scc1 L2_iok
    s_mov_b32 s56, s30
    s_and_b32 s57, s31, 0xffff
    s_mov_b32 s58, 256
    s_mov_b32 s59, 0x00020000
    s_mov_b32 s15, 0
L2_ichk:
    buffer_load_dword v4, v3, s[56:59], 0 offen sc1
    s_waitcnt vmcnt(0)
    v_readfirstlane_b32 s14, v4
    s_add_u32 s15, s15, 1
    s_cmp_ge_u32 s14, 96
    s_cbranch_scc1 L2_ichk_ok
    s_sleep 8
    s_cmp_lt_u32 s15, 0x40000
    s_cbranch_scc1 L2_ichk
L2_ichk_ok:
L2_iok:
    s_mov_b32 s15, 0
L2_pollx:
    buffer_load_dword v4, v3, s[48:51], s13 offen sc1
    s_waitcnt vmcnt(0)
    v_readfirstlane_b32 s14, v4
    s_add_u32 s15, s15, 1
    s_cmp_ge_u32 s14, 5
    s_cbranch_scc1 L2_pollx_ok
    s_sleep 8
    s_cmp_lt_u32 s15, 0x40000
    s_cbranch_scc1 L2_pollx
L2_pollx_ok:
L2_xwait:
    s_waitcnt vmcnt(0)
    s_barrier
    s_add_u32 s14, s10, 0
    buffer_load_dwordx4 v[8:11], v1, s[36:39], s14 offen offset:0 sc1
    buffer_load_dwordx4 v[12:15], v1, s[36:39], s14 offen offset:1024 sc1
    buffer_load_dwordx4 v[16:19], v1, s[36:39], s14 offen offset:2048 sc1
    buffer_load_dwordx4 v[20:23], v1, s[36:39], s14 offen offset:3072 sc1
    s_add_u32 s14, s10, 4096
    buffer_load_dwordx4 v[24:27], v1, s[36:39], s14 offen offset:0 sc1
    buffer_load_dwordx4 v[28:31], v1, s[36:39], s14 offen offset:1024 sc1
    buffer_load_dwordx4 v[32:35], v1, s[36:39], s14 offen offset:2048 sc1
    buffer_load_dwordx4 v[36:39], v1, s[36:39], s14 offen offset:3072 sc1
    s_add_u32 s14, s10, 8192
    buffer_load_dwordx4 v[40:43], v1, s[36:39], s14 offen offset:0 sc1
    buffer_load_dwordx4 v[44:47], v1, s[36:39], s14 offen offset:1024 sc1
    buffer_load_dwordx4 v[48:51], v1, s[36:39], s14 offen offset:2048 sc1
    buffer_load_dwordx4 v[52:55], v1, s[36:39], s14 offen offset:3072 sc1
    s_add_u32 s14, s10, 12288
    buffer_load_dwordx4 v[56:59], v1, s[36:39], s14 offen offset:0 sc1
    buffer_load_dwordx4 v[60:63], v1, s[36:39], s14 offen offset:1024 sc1
    buffer_load_dwordx4 v[64:67], v1, s[36:39], s14 offen offset:2048 sc1
    buffer_load_dwordx4 v[68:71], v1, s[36:39], s14 offen offset:3072 sc1
    s_waitcnt vmcnt(12)
    s_barrier
    ds_read_b128 v[216:219], v1 offset:0
    ds_read_b128 v[220:223], v1 offset:40960
    ds_read_b128 v[224:227], v2 offset:16384
    ds_read_b128 v[228:231], v1 offset:1024
    ds_read_b128 v[232:235], v1 offset:41984
    ds_read_b128 v[236:239], v2 offset:17408
    s_waitcnt lgkmcnt(3)
    v_mfma_f32_32x32x16_bf16 v[168:183], v[216:219], v[8:11], 0
    ds_read_b128 v[240:243], v1 offset:2048
    ds_read_b128 v[244:247], v1 offset:43008
    ds_read_b128 v[248:251], v2 offset:18432
    v_mfma_f32_32x32x16_bf16 v[184:199], v[220:223], v[8:11], 0
    s_add_u32 s14, s10, 16384
    buffer_load_dwordx4 v[72:75], v1, s[36:39], s14 offen offset:0 sc1
    v_mfma_f32_32x32x16_bf16 v[200:215], v[224:227], v[8:11], 0
    buffer_load_dwordx4 v[76:79], v1, s[36:39], s14 offen offset:1024 sc1
    s_waitcnt lgkmcnt(3)
    v_mfma_f32_32x32x16_bf16 v[168:183], v[228:231], v[12:15], v[168:183]
    ds_read_b128 v[216:219], v1 offset:3072
    ds_read_b128 v[220:223], v1 offset:44032
    ds_read_b128 v[224:227], v2 offset:19456
    v_mfma_f32_32x32x16_bf16 v[184:199], v[232:235], v[12:15], v[184:199]
    buffer_load_dwordx4 v[80:83], v1, s[36:39], s14 offen offset:2048 sc1
    v_mfma_f32_32x32x16_bf16 v[200:215], v[236:239], v[12:15], v[200:215]
    buffer_load_dwordx4 v[84:87], v1, s[36:39], s14 offen offset:3072 sc1
    s_waitcnt lgkmcnt(3)
    v_mfma_f32_32x32x16_bf16 v[168:183], v[240:243], v[16:19], v[168:183]
    s_waitcnt vmcnt(12)
    s_barrier
    ds_read_b128 v[228:231], v1 offset:4096
    ds_read_b128 v[232:235], v1 offset:45056
    ds_read_b128 v[236:239], v2 offset:20480
    v_mfma_f32_32x32x16_bf16 v[184:199], v[244:247], v[16:19], v[184:199]
    s_add_u32 s14, s10, 20480
    buffer_load_dwordx4 v[88:91], v1, s[36:39], s14 offen offset:0 sc1
    v_mfma_f32_32x32x16_bf16 v[200:215], v[248:251], v[16:19], v[200:215]
    buffer_load_dwordx4 v[92:95], v1, s[36:39], s14 offen offset:1024 sc1
    s_waitcnt lgkmcnt(3)
    v_mfma_f32_32x32x16_bf16 v[168:183], v[216:219], v[20:23], v[168:183]
    ds_read_b128 v[240:243], v1 offset:5120
    ds_read_b128 v[244:247], v1 offset:46080
    ds_read_b128 v[248:251], v2 offset:21504
    v_mfma_f32_32x32x16_bf16 v[184:199], v[220:223], v[20:23], v[184:199]
    buffer_load_dwordx4 v[96:99], v1, s[36:39], s14 offen offset:2048 sc1
    v_mfma_f32_32x32x16_bf16 v[200:215], v[224:227], v[20:23], v[200:215]
    buffer_load_dwordx4 v[100:103], v1, s[36:39], s14 offen offset:3072 sc1
    s_waitcnt lgkmcnt(3)
    v_mfma_f32_32x32x16_bf16 v[168:183], v[228:231], v[24:27], v[168:183]
    ds_read_b128 v[216:219], v1 offset:6144
    ds_read_b128 v[220:223], v1 offset:47104
    ds_read_b128 v[224:227], v2 offset:22528
    v_mfma_f32_32x32x16_bf16 v[184:199], v[232:235], v[24:27], v[184:199]
    v_mfma_f32_32x32x16_bf16 v[200:215], v[236:239], v[24:27], v[200:215]
    s_waitcnt lgkmcnt(3)
    v_mfma_f32_32x32x16_bf16 v[168:183], v[240:243], v[28:31], v[168:183]
    ds_read_b128 v[228:231], v1 offset:7168
    ds_read_b128 v[232:235], v1 offset:48128
    ds_read_b128 v[236:239], v2 offset:23552
    v_mfma_f32_32x32x16_bf16 v[184:199], v[244:247], v[28:31], v[184:199]
    v_mfma_f32_32x32x16_bf16 v[200:215], v[248:251], v[28:31], v[200:215]
    s_waitcnt lgkmcnt(3)
    v_mfma_f32_32x32x16_bf16 v[168:183], v[216:219], v[32:35], v[168:183]
    s_waitcnt vmcnt(12)
    s_barrier
    ds_read_b128 v[240:243], v1 offset:8192
    ds_read_b128 v[244:247], v1 offset:49152
    ds_read_b128 v[248:251], v2 offset:24576
    v_mfma_f32_32x32x16_bf16 v[184:199], v[220:223], v[32:35], v[184:199]
    s_add_u32 s14, s10, 24576
    buffer_load_dwordx4 v[104:107], v1, s[36:39], s14 offen offset:0 sc1
    v_mfma_f32_32x32x16_bf16 v[200:215], v[224:227], v[32:35], v[200:215]
    buffer_load_dwordx4 v[108:111], v1, s[36:39], s14 offen offset:1024 sc1
    s_waitcnt lgkmcnt(3)
    v_mfma_f32_32x32x16_bf16 v[168:183], v[228:231], v[36:39], v[168:183]
    ds_read_b128 v[216:219], v1 offset:9216
    ds_read_b128 v[220:223], v1 offset:50176
    ds_read_b128 v[224:227], v2 offset:25600
    v_mfma_f32_32x32x16_bf16 v[184:199], v[232:235], v[36:39], v[184:199]
    buffer_load_dwordx4 v[112:115], v1, s[36:39], s14 offen offset:2048 sc1
    v_mfma_f32_32x32x16_bf16 v[200:215], v[236:239], v[36:39], v[200:215]
    buffer_load_dwordx4 v[116:119], v1, s[36:39], s14 offen offset:3072 sc1
    s_waitcnt lgkmcnt(3)
    v_mfma_f32_32x32x16_bf16 v[168:183], v[240:243], v[40:43], v[168:183]
    ds_read_b128 v[228:231], v1 offset:10240
    ds_read_b128 v[232:235], v1 offset:51200
    ds_read_b128 v[236:239], v2 offset:26624
    v_mfma_f32_32x32x16_bf16 v[184:199], v[244:247], v[40:43], v[184:199]
    v_mfma_f32_32x32x16_bf16 v[200:215], v[248:251], v[40:43], v[200:215]
    s_waitcnt lgkmcnt(3)
    v_mfma_f32_32x32x16_bf16 v[168:183], v[216:219], v[44:47], v[168:183]
    ds_read_b128 v[240:243], v1 offset:11264
    ds_read_b128 v[244:247], v1 offset:52224
    ds_read_b128 v[248:251], v2 offset:27648
    v_mfma_f32_32x32x16_bf16 v[184:199], v[220:223], v[44:47], v[184:199]
    v_mfma_f32_32x32x16_bf16 v[200:215], v[224:227], v[44:47], v[200:215]
    s_waitcnt lgkmcnt(3)
    v_mfma_f32_32x32x16_bf16 v[168:183], v[228:231], v[48:51], v[168:183]
    s_waitcnt vmcnt(12)
    s_barrier
    ds_read_b128 v[216:219], v1 offset:12288
    ds_read_b128 v[220:223], v1 offset:53248
    ds_read_b128 v[224:227], v2 offset:28672
    v_mfma_f32_32x32x16_bf16 v[184:199], v[232:235], v[48:51], v[184:199]
    s_add_u32 s14, s10, 28672
    buffer_load_dwordx4 v[120:123], v1, s[36:39], s14 offen offset:0 sc1
    v_mfma_f32_32x32x16_bf16 v[200:215], v[236:239], v[48:51], v[200:215]
    buffer_load_dwordx4 v[124:127], v1, s[36:39], s14 offen offset:1024 sc1
    s_waitcnt lgkmcnt(3)
    v_mfma_f32_32x32x16_bf16 v[168:183], v[240:243], v[52:55], v[168:183]
    ds_read_b128 v[228:231], v1 offset:13312
    ds_read_b128 v[232:235], v1 offset:54272
    ds_read_b128 v[236:239], v2 offset:29696
    v_mfma_f32_32x32x16_bf16 v[184:199], v[244:247], v[52:55], v[184:199]
    buffer_load_dwordx4 v[128:131], v1, s[36:39], s14 offen offset:2048 sc1
    v_mfma_f32_32x32x16_bf16 v[200:215], v[248:251], v[52:55], v[200:215]
    buffer_load_dwordx4 v[132:135], v1, s[36:39], s14 offen offset:3072 sc1
    s_waitcnt lgkmcnt(3)
    v_mfma_f32_32x32x16_bf16 v[168:183], v[216:219], v[56:59], v[168:183]
    ds_read_b128 v[240:243], v1 offset:14336
    ds_read_b128 v[244:247], v1 offset:55296
    ds_read_b128 v[248:251], v2 offset:30720
    v_mfma_f32_32x32x16_bf16 v[184:199], v[220:223], v[56:59], v[184:199]
    v_mfma_f32_32x32x16_bf16 v[200:215], v[224:227], v[56:59], v[200:215]
    s_waitcnt lgkmcnt(3)
    v_mfma_f32_32x32x16_bf16 v[168:183], v[228:231], v[60:63], v[168:183]
    ds_read_b128 v[216:219], v1 offset:15360
    ds_read_b128 v[220:223], v1 offset:56320
    ds_read_b128 v[224:227], v2 offset:31744
    v_mfma_f32_32x32x16_bf16 v[184:199], v[232:235], v[60:63], v[184:199]
    v_mfma_f32_32x32x16_bf16 v[200:215], v[236:239], v[60:63], v[200:215]
    s_waitcnt lgkmcnt(3)
    v_mfma_f32_32x32x16_bf16 v[168:183], v[240:243], v[64:67], v[168:183]
    s_waitcnt vmcnt(12)
    s_barrier
    ds_read_b128 v[228:231], v1 offset:16384
    ds_read_b128 v[232:235], v1 offset:57344
    ds_read_b128 v[236:239], v2 offset:32768
    v_mfma_f32_32x32x16_bf16 v[184:199], v[244:247], v[64:67], v[184:199]
    s_add_u32 s14, s10, 32768
    buffer_load_dwordx4 v[136:139], v1, s[36:39], s14 offen offset:0 sc1
    v_mfma_f32_32x32x16_bf16 v[200:215], v[248:251], v[64:67], v[200:215]
    buffer_load_dwordx4 v[140:143], v1, s[36:39], s14 offen offset:1024 sc1
    s_waitcnt lgkmcnt(3)
    v_mfma_f32_32x32x16_bf16 v[168:183], v[216:219], v[68:71], v[168:183]
    ds_read_b128 v[240:243], v1 offset:17408
    ds_read_b128 v[244:247], v1 offset:58368
    ds_read_b128 v[248:251], v2 offset:33792
    v_mfma_f32_32x32x16_bf16 v[184:199], v[220:223], v[68:71], v[184:199]
    buffer_load_dwordx4 v[144:147], v1, s[36:39], s14 offen offset:2048 sc1
    v_mfma_f32_32x32x16_bf16 v[200:215], v[224:227], v[68:71], v[200:215]
    buffer_load_dwordx4 v[148:151], v1, s[36:39], s14 offen offset:3072 sc1
    s_waitcnt lgkmcnt(3)
    v_mfma_f32_32x32x16_bf16 v[168:183], v[228:231], v[72:75], v[168:183]
    ds_read_b128 v[216:219], v1 offset:18432
    ds_read_b128 v[220:223], v1 offset:59392
    ds_read_b128 v[224:227], v2 offset:34816
    v_mfma_f32_32x32x16_bf16 v[184:199], v[232:235], v[72:75], v[184:199]
    v_mfma_f32_32x32x16_bf16 v[200:215], v[236:239], v[72:75], v[200:215]
    s_waitcnt lgkmcnt(3)
    v_mfma_f32_32x32x16_bf16 v[168:183], v[240:243], v[76:79], v[168:183]
    ds_read_b128 v[228:231], v1 offset:19456
    ds_read_b128 v[232:235], v1 offset:60416
    ds_read_b128 v[236:239], v2 offset:35840
    v_mfma_f32_32x32x16_bf16 v[184:199], v[244:247], v[76:79], v[184:199]
    v_mfma_f32_32x32x16_bf16 v[200:215], v[248:251], v[76:79], v[200:215]
    s_waitcnt lgkmcnt(3)
    v_mfma_f32_32x32x16_bf16 v[168:183], v[216:219], v[80:83], v[168:183]
    s_waitcnt vmcnt(12)
    s_barrier
    ds_read_b128 v[240:243], v1 offset:20480
    ds_read_b128 v[244:247], v1 offset:61440
    ds_read_b128 v[248:251], v2 offset:36864
    v_mfma_f32_32x32x16_bf16 v[184:199], v[220:223], v[80:83], v[184:199]
    s_add_u32 s14, s10, 36864
    buffer_load_dwordx4 v[152:155], v1, s[36:39], s14 offen offset:0 sc1
    v_mfma_f32_32x32x16_bf16 v[200:215], v[224:227], v[80:83], v[200:215]
    buffer_load_dwordx4 v[156:159], v1, s[36:39], s14 offen offset:1024 sc1
    s_waitcnt lgkmcnt(3)
    v_mfma_f32_32x32x16_bf16 v[168:183], v[228:231], v[84:87], v[168:183]
    ds_read_b128 v[216:219], v1 offset:21504
    ds_read_b128 v[220:223], v1 offset:62464
    ds_read_b128 v[224:227], v2 offset:37888
    v_mfma_f32_32x32x16_bf16 v[184:199], v[232:235], v[84:87], v[184:199]
    buffer_load_dwordx4 v[160:163], v1, s[36:39], s14 offen offset:2048 sc1
    v_mfma_f32_32x32x16_bf16 v[200:215], v[236:239], v[84:87], v[200:215]
    buffer_load_dwordx4 v[164:167], v1, s[36:39], s14 offen offset:3072 sc1
    s_waitcnt lgkmcnt(3)
    v_mfma_f32_32x32x16_bf16 v[168:183], v[240:243], v[88:91], v[168:183]
    ds_read_b128 v[228:231], v1 offset:22528
    ds_read_b128 v[232:235], v1 offset:63488
    ds_read_b128 v[236:239], v2 offset:38912
    v_mfma_f32_32x32x16_bf16 v[184:199], v[244:247], v[88:91], v[184:199]
    v_mfma_f32_32x32x16_bf16 v[200:215], v[248:251], v[88:91], v[200:215]
    s_waitcnt lgkmcnt(3)
    v_mfma_f32_32x32x16_bf16 v[168:183], v[216:219], v[92:95], v[168:183]
    ds_read_b128 v[240:243], v1 offset:23552
    ds_read_b128 v[244:247], v1 offset:64512
    ds_read_b128 v[248:251], v2 offset:39936
    v_mfma_f32_32x32x16_bf16 v[184:199], v[220:223], v[92:95], v[184:199]
    v_mfma_f32_32x32x16_bf16 v[200:215], v[224:227], v[92:95], v[200:215]
    s_waitcnt lgkmcnt(3)
    v_mfma_f32_32x32x16_bf16 v[168:183], v[228:231], v[96:99], v[168:183]
    s_waitcnt vmcnt(12)
    s_barrier
    ds_read_b128 v[216:219], v1 offset:24576
    ds_read_b128 v[220:223], v2 offset:0
    ds_read_b128 v[224:227], v2 offset:40960
    v_mfma_f32_32x32x16_bf16 v[184:199], v[232:235], v[96:99], v[184:199]
    v_mfma_f32_32x32x16_bf16 v[200:215], v[236:239], v[96:99], v[200:215]
    s_waitcnt lgkmcnt(3)
    v_mfma_f32_32x32x16_bf16 v[168:183], v[240:243], v[100:103], v[168:183]
    ds_read_b128 v[228:231], v1 offset:25600
    ds_read_b128 v[232:235], v2 offset:1024
    ds_read_b128 v[236:239], v2 offset:41984
    v_mfma_f32_32x32x16_bf16 v[184:199], v[244:247], v[100:103], v[184:199]
    v_mfma_f32_32x32x16_bf16 v[200:215], v[248:251], v[100:103], v[200:215]
    s_waitcnt lgkmcnt(3)
    v_mfma_f32_32x32x16_bf16 v[168:183], v[216:219], v[104:107], v[168:183]
    ds_read_b128 v[240:243], v1 offset:26624
    ds_read_b128 v[244:247], v2 offset:2048
    ds_read_b128 v[248:251], v2 offset:43008
    v_mfma_f32_32x32x16_bf16 v[184:199], v[220:223], v[104:107], v[184:199]
    v_mfma_f32_32x32x16_bf16 v[200:215], v[224:227], v[104:107], v[200:215]
    s_waitcnt lgkmcnt(3)
    v_mfma_f32_32x32x16_bf16 v[168:183], v[228:231], v[108:111], v[168:183]
    ds_read_b128 v[216:219], v1 offset:27648
    ds_read_b128 v[220:223], v2 offset:3072
    ds_read_b128 v[224:227], v2 offset:44032
    v_mfma_f32_32x32x16_bf16 v[184:199], v[232:235], v[108:111], v[184:199]
    v_mfma_f32_32x32x16_bf16 v[200:215], v[236:239], v[108:111], v[200:215]
    s_waitcnt lgkmcnt(3)
    v_mfma_f32_32x32x16_bf16 v[168:183], v[240:243], v[112:115], v[168:183]
    s_waitcnt vmcnt(8)
    s_barrier
    ds_read_b128 v[228:231], v1 offset:28672
    ds_read_b128 v[232:235], v2 offset:4096
    ds_read_b128 v[236:239], v2 offset:45056
    v_mfma_f32_32x32x16_bf16 v[184:199], v[244:247], v[112:115], v[184:199]
    v_mfma_f32_32x32x16_bf16 v[200:215], v[248:251], v[112:115], v[200:215]
    s_waitcnt lgkmcnt(3)
    v_mfma_f32_32x32x16_bf16 v[168:183], v[216:219], v[116:119], v[168:183]
    ds_read_b128 v[240:243], v1 offset:29696
    ds_read_b128 v[244:247], v2 offset:5120
    ds_read_b128 v[248:251], v2 offset:46080
    v_mfma_f32_32x32x16_bf16 v[184:199], v[220:223], v[116:119], v[184:199]
    v_mfma_f32_32x32x16_bf16 v[200:215], v[224:227], v[116:119], v[200:215]
    s_waitcnt lgkmcnt(3)
    v_mfma_f32_32x32x16_bf16 v[168:183], v[228:231], v[120:123], v[168:183]
    ds_read_b128 v[216:219], v1 offset:30720
    ds_read_b128 v[220:223], v2 offset:6144
    ds_read_b128 v[224:227], v2 offset:47104
    v_mfma_f32_32x32x16_bf16 v[184:199], v[232:235], v[120:123], v[184:199]
    v_mfma_f32_32x32x16_bf16 v[200:215], v[236:239], v[120:123], v[200:215]
    s_waitcnt lgkmcnt(3)
    v_mfma_f32_32x32x16_bf16 v[168:183], v[240:243], v[124:127], v[168:183]
    ds_read_b128 v[228:231], v1 offset:31744
    ds_read_b128 v[232:235], v2 offset:7168
    ds_read_b128 v[236:239], v2 offset:48128
    v_mfma_f32_32x32x16_bf16 v[184:199], v[244:247], v[124:127], v[184:199]
    v_mfma_f32_32x32x16_bf16 v[200:215], v[248:251], v[124:127], v[200:215]
    s_waitcnt lgkmcnt(3)
    v_mfma_f32_32x32x16_bf16 v[168:183], v[216:219], v[128:131], v[168:183]
    s_waitcnt vmcnt(4)
    s_barrier
    ds_read_b128 v[240:243], v1 offset:32768
    ds_read_b128 v[244:247], v2 offset:8192
    ds_read_b128 v[248:251], v2 offset:49152
    v_mfma_f32_32x32x16_bf16 v[184:199], v[220:223], v[128:131], v[184:199]
    v_mfma_f32_32x32x16_bf16 v[200:215], v[224:227], v[128:131], v[200:215]
    s_waitcnt lgkmcnt(3)
    v_mfma_f32_32x32x16_bf16 v[168:183], v[228:231], v[132:135], v[168:183]
    ds_read_b128 v[216:219], v1 offset:33792
    ds_read_b128 v[220:223], v2 offset:9216
    ds_read_b128 v[224:227], v2 offset:50176
    v_mfma_f32_32x32x16_bf16 v[184:199], v[232:235], v[132:135], v[184:199]
    v_mfma_f32_32x32x16_bf16 v[200:215], v[236:239], v[132:135], v[200:215]
    s_waitcnt lgkmcnt(3)
    v_mfma_f32_32x32x16_bf16 v[168:183], v[240:243], v[136:139], v[168:183]
    ds_read_b128 v[228:231], v1 offset:34816
    ds_read_b128 v[232:235], v2 offset:10240
    ds_read_b128 v[236:239], v2 offset:51200
    v_mfma_f32_32x32x16_bf16 v[184:199], v[244:247], v[136:139], v[184:199]
    v_mfma_f32_32x32x16_bf16 v[200:215], v[248:251], v[136:139], v[200:215]
    s_waitcnt lgkmcnt(3)
    v_mfma_f32_32x32x16_bf16 v[168:183], v[216:219], v[140:143], v[168:183]
    ds_read_b128 v[240:243], v1 offset:35840
    ds_read_b128 v[244:247], v2 offset:11264
    ds_read_b128 v[248:251], v2 offset:52224
    v_mfma_f32_32x32x16_bf16 v[184:199], v[220:223], v[140:143], v[184:199]
    v_mfma_f32_32x32x16_bf16 v[200:215], v[224:227], v[140:143], v[200:215]
    s_waitcnt lgkmcnt(3)
    v_mfma_f32_32x32x16_bf16 v[168:183], v[228:231], v[144:147], v[168:183]
    s_waitcnt vmcnt(0)
    s_barrier
    ds_read_b128 v[216:219], v1 offset:36864
    ds_read_b128 v[220:223], v2 offset:12288
    ds_read_b128 v[224:227], v2 offset:53248
    v_mfma_f32_32x32x16_bf16 v[184:199], v[232:235], v[144:147], v[184:199]
    v_mfma_f32_32x32x16_bf16 v[200:215], v[236:239], v[144:147], v[200:215]
    s_waitcnt lgkmcnt(3)
    v_mfma_f32_32x32x16_bf16 v[168:183], v[240:243], v[148:151], v[168:183]
    ds_read_b128 v[228:231], v1 offset:37888
    ds_read_b128 v[232:235], v2 offset:13312
    ds_read_b128 v[236:239], v2 offset:54272
    v_mfma_f32_32x32x16_bf16 v[184:199], v[244:247], v[148:151], v[184:199]
    v_mfma_f32_32x32x16_bf16 v[200:215], v[248:251], v[148:151], v[200:215]
    s_waitcnt lgkmcnt(3)
    v_mfma_f32_32x32x16_bf16 v[168:183], v[216:219], v[152:155], v[168:183]
    ds_read_b128 v[240:243], v1 offset:38912
    ds_read_b128 v[244:247], v2 offset:14336
    ds_read_b128 v[248:251], v2 offset:55296
    v_mfma_f32_32x32x16_bf16 v[184:199], v[220:223], v[152:155], v[184:199]
    v_mfma_f32_32x32x16_bf16 v[200:215], v[224:227], v[152:155], v[200:215]
    s_waitcnt lgkmcnt(3)
    v_mfma_f32_32x32x16_bf16 v[168:183], v[228:231], v[156:159], v[168:183]
    ds_read_b128 v[216:219], v1 offset:39936
    ds_read_b128 v[220:223], v2 offset:15360
    ds_read_b128 v[224:227], v2 offset:56320
    v_mfma_f32_32x32x16_bf16 v[184:199], v[232:235], v[156:159], v[184:199]
    v_mfma_f32_32x32x16_bf16 v[200:215], v[236:239], v[156:159], v[200:215]
    s_waitcnt lgkmcnt(3)
    v_mfma_f32_32x32x16_bf16 v[168:183], v[240:243], v[160:163], v[168:183]
    v_mfma_f32_32x32x16_bf16 v[184:199], v[244:247], v[160:163], v[184:199]
    v_mfma_f32_32x32x16_bf16 v[200:215], v[248:251], v[160:163], v[200:215]
    s_waitcnt lgkmcnt(0)
    v_mfma_f32_32x32x16_bf16 v[168:183], v[216:219], v[164:167], v[168:183]
    v_mfma_f32_32x32x16_bf16 v[184:199], v[220:223], v[164:167], v[184:199]
    v_mfma_f32_32x32x16_bf16 v[200:215], v[224:227], v[164:167], v[200:215]
    v_and_b32 v3, 31, v0
    v_lshrrev_b32 v4, 5, v0
    s_lshl_b32 s9, s9, 5
    v_add_u32 v3, s9, v3
    v_mul_u32_u24 v3, 3072, v3
    v_lshl_add_u32 v3, v4, 4, v3
    s_mul_i32 s12, s8, 192
    s_nop 7
    v_cvt_pk_bf16_f32 v8, v168, v169
    v_cvt_pk_bf16_f32 v9, v170, v171
    v_cvt_pk_bf16_f32 v10, v172, v173
    v_cvt_pk_bf16_f32 v11, v174, v175
    v_cvt_pk_bf16_f32 v12, v176, v177
    v_cvt_pk_bf16_f32 v13, v178, v179
    v_cvt_pk_bf16_f32 v14, v180, v181
    v_cvt_pk_bf16_f32 v15, v182, v183
    s_nop 1
    v_permlane32_swap_b32 v8, v10
    v_permlane32_swap_b32 v9, v11
    v_permlane32_swap_b32 v12, v14
    v_permlane32_swap_b32 v13, v15
    buffer_store_dwordx4 v[8:11], v3, s[44:47], s12 offen offset:0
    buffer_store_dwordx4 v[12:15], v3, s[44:47], s12 offen offset:32
    v_cvt_pk_bf16_f32 v16, v184, v185
    v_cvt_pk_bf16_f32 v17, v186, v187
    v_cvt_pk_bf16_f32 v18, v188, v189
    v_cvt_pk_bf16_f32 v19, v190, v191
    v_cvt_pk_bf16_f32 v20, v192, v193
    v_cvt_pk_bf16_f32 v21, v194, v195
    v_cvt_pk_bf16_f32 v22, v196, v197
    v_cvt_pk_bf16_f32 v23, v198, v199
    s_nop 1
    v_permlane32_swap_b32 v16, v18
    v_permlane32_swap_b32 v17, v19
    v_permlane32_swap_b32 v20, v22
    v_permlane32_swap_b32 v21, v23
    buffer_store_dwordx4 v[16:19], v3, s[44:47], s12 offen offset:64
    buffer_store_dwordx4 v[20:23], v3, s[44:47], s12 offen offset:96
    v_cvt_pk_bf16_f32 v24, v200, v201
    v_cvt_pk_bf16_f32 v25, v202, v203
    v_cvt_pk_bf16_f32 v26, v204, v205
    v_cvt_pk_bf16_f32 v27, v206, v207
    v_cvt_pk_bf16_f32 v28, v208, v209
    v_cvt_pk_bf16_f32 v29, v210, v211
    v_cvt_pk_bf16_f32 v30, v212, v213
    v_cvt_pk_bf16_f32 v31, v214, v215
    s_nop 1
    v_permlane32_swap_b32 v24, v26
    v_permlane32_swap_b32 v25, v27
    v_permlane32_swap_b32 v28, v30
    v_permlane32_swap_b32 v29, v31
    buffer_store_dwordx4 v[24:27], v3, s[44:47], s12 offen offset:128
    buffer_store_dwordx4 v[28:31], v3, s[44:47], s12 offen offset:160
    s_endpgm
L2_load:
    s_cmp_lg_u32 s4, 4
    s_cbranch_scc1 L_end
    s_lshr_b32 s7, s5, 1
    s_lshl_b32 s7, s7, 2
    s_and_b32 s8, s6, 3
    s_add_u32 s7, s7, s8
    s_and_b32 s8, s5, 1
    s_lshl_b32 s8, s8, 3
    s_lshr_b32 s9, s6, 2
    s_add_u32 s8, s8, s9
    v_lshlrev_b32 v1, 4, v0
    v_mov_b32 v3, 0
    s_add_u32 s48, s32, 6291456
    s_addc_u32 s49, s33, 0
    s_and_b32 s49, s49, 0xffff
    s_mov_b32 s50, 32768
    s_mov_b32 s51, 0x00020000
    s_lshl_b32 s13, s2, 7
    s_mul_i32 s12, s8, 122880
    s_add_u32 s12, s12, 3145728
    s_add_u32 s40, s32, s12
    s_addc_u32 s41, s33, 0
    s_and_b32 s41, s41, 0xffff
    s_mov_b32 s42, 122880
    s_mov_b32 s43, 0x00020000
    s_barrier
    s_mov_b32 s15, 0
L2_pollt:
    buffer_load_dword v4, v3, s[48:51], s13 offen offset:4 sc1
    s_waitcnt vmcnt(0)
    v_readfirstlane_b32 s14, v4
    s_add_u32 s15, s15, 1
    s_cmp_ge_u32 s14, 10
    s_cbranch_scc1 L2_pollt_ok
    s_sleep 8
    s_cmp_lt_u32 s15, 0x40000
    s_cbranch_scc1 L2_pollt
L2_pollt_ok:
    s_mov_b32 s12, 0
    s_mov_b32 m0, s12
    s_nop 0
    buffer_load_dwordx4 v1, s[40:43], s12 offen offset:0 sc1 lds
    buffer_load_dwordx4 v1, s[40:43], s12 offen offset:1024 sc1 lds
    buffer_load_dwordx4 v1, s[40:43], s12 offen offset:2048 sc1 lds
    buffer_load_dwordx4 v1, s[40:43], s12 offen offset:3072 sc1 lds
    s_mov_b32 s12, 40960
    s_mov_b32 m0, s12
    s_nop 0
    buffer_load_dwordx4 v1, s[40:43], s12 offen offset:0 sc1 lds
    buffer_load_dwordx4 v1, s[40:43], s12 offen offset:1024 sc1 lds
    buffer_load_dwordx4 v1, s[40:43], s12 offen offset:2048 sc1 lds
    buffer_load_dwordx4 v1, s[40:43], s12 offen offset:3072 sc1 lds
    s_mov_b32 s12, 81920
    s_mov_b32 m0, s12
    s_nop 0
    buffer_load_dwordx4 v1, s[40:43], s12 offen offset:0 sc1 lds
    buffer_load_dwordx4 v1, s[40:43], s12 offen offset:1024 sc1 lds
    buffer_load_dwordx4 v1, s[40:43], s12 offen offset:2048 sc1 lds
    buffer_load_dwordx4 v1, s[40:43], s12 offen offset:3072 sc1 lds
    s_mov_b32 s12, 4096
    s_mov_b32 m0, s12
    s_nop 0
    buffer_load_dwordx4 v1, s[40:43], s12 offen offset:0 sc1 lds
    buffer_load_dwordx4 v1, s[40:43], s12 offen offset:1024 sc1 lds
    buffer_load_dwordx4 v1, s[40:43], s12 offen offset:2048 sc1 lds
    buffer_load_dwordx4 v1, s[40:43], s12 offen offset:3072 sc1 lds
    s_mov_b32 s12, 45056
    s_mov_b32 m0, s12
    s_nop 0
    buffer_load_dwordx4 v1, s[40:43], s12 offen offset:0 sc1 lds
    buffer_load_dwordx4 v1, s[40:43], s12 offen offset:1024 sc1 lds
    buffer_load_dwordx4 v1, s[40:43], s12 offen offset:2048 sc1 lds
    buffer_load_dwordx4 v1, s[40:43], s12 offen offset:3072 sc1 lds
    s_mov_b32 s12, 86016
    s_mov_b32 m0, s12
    s_nop 0
    buffer_load_dwordx4 v1, s[40:43], s12 offen offset:0 sc1 lds
    buffer_load_dwordx4 v1, s[40:43], s12 offen offset:1024 sc1 lds
    buffer_load_dwordx4 v1, s[40:43], s12 offen offset:2048 sc1 lds
    buffer_load_dwordx4 v1, s[40:43], s12 offen offset:3072 sc1 lds
    s_mov_b32 s12, 8192
    s_mov_b32 m0, s12
    s_nop 0
    buffer_load_dwordx4 v1, s[40:43], s12 offen offset:0 sc1 lds
    buffer_load_dwordx4 v1, s[40:43], s12 offen offset:1024 sc1 lds
    buffer_load_dwordx4 v1, s[40:43], s12 offen offset:2048 sc1 lds
    buffer_load_dwordx4 v1, s[40:43], s12 offen offset:3072 sc1 lds
    s_mov_b32 s12, 49152
    s_mov_b32 m0, s12
    s_nop 0
    buffer_load_dwordx4 v1, s[40:43], s12 offen offset:0 sc1 lds
    buffer_load_dwordx4 v1, s[40:43], s12 offen offset:1024 sc1 lds
    buffer_load_dwordx4 v1, s[40:43], s12 offen offset:2048 sc1 lds
    buffer_load_dwordx4 v1, s[40:43], s12 offen offset:3072 sc1 lds
    s_mov_b32 s12, 90112
    s_mov_b32 m0, s12
    s_nop 0
    buffer_load_dwordx4 v1, s[40:43], s12 offen offset:0 sc1 lds
    buffer_load_dwordx4 v1, s[40:43], s12 offen offset:1024 sc1 lds
    buffer_load_dwordx4 v1, s[40:43], s12 offen offset:2048 sc1 lds
    buffer_load_dwordx4 v1, s[40:43], s12 offen offset:3072 sc1 lds
    s_waitcnt vmcnt(24)
    s_barrier
    s_mov_b32 s12, 12288
    s_mov_b32 m0, s12
    s_nop 0
    buffer_load_dwordx4 v1, s[40:43], s12 offen offset:0 sc1 lds
    buffer_load_dwordx4 v1, s[40:43], s12 offen offset:1024 sc1 lds
    buffer_load_dwordx4 v1, s[40:43], s12 offen offset:2048 sc1 lds
    buffer_load_dwordx4 v1, s[40:43], s12 offen offset:3072 sc1 lds
    s_mov_b32 s12, 53248
    s_mov_b32 m0, s12
    s_nop 0
    buffer_load_dwordx4 v1, s[40:43], s12 offen offset:0 sc1 lds
    buffer_load_dwordx4 v1, s[40:43], s12 offen offset:1024 sc1 lds
    buffer_load_dwordx4 v1, s[40:43], s12 offen offset:2048 sc1 lds
    buffer_load_dwordx4 v1, s[40:43], s12 offen offset:3072 sc1 lds
    s_mov_b32 s12, 94208
    s_mov_b32 m0, s12
    s_nop 0
    buffer_load_dwordx4 v1, s[40:43], s12 offen offset:0 sc1 lds
    buffer_load_dwordx4 v1, s[40:43], s12 offen offset:1024 sc1 lds
    buffer_load_dwordx4 v1, s[40:43], s12 offen offset:2048 sc1 lds
    buffer_load_dwordx4 v1, s[40:43], s12 offen offset:3072 sc1 lds
    s_waitcnt vmcnt(24)
    s_barrier
    s_mov_b32 s12, 16384
    s_mov_b32 m0, s12
    s_nop 0
    buffer_load_dwordx4 v1, s[40:43], s12 offen offset:0 sc1 lds
    buffer_load_dwordx4 v1, s[40:43], s12 offen offset:1024 sc1 lds
    buffer_load_dwordx4 v1, s[40:43], s12 offen offset:2048 sc1 lds
    buffer_load_dwordx4 v1, s[40:43], s12 offen offset:3072 sc1 lds
    s_mov_b32 s12, 57344
    s_mov_b32 m0, s12
    s_nop 0
    buffer_load_dwordx4 v1, s[40:43], s12 offen offset:0 sc1 lds
    buffer_load_dwordx4 v1, s[40:43], s12 offen offset:1024 sc1 lds
    buffer_load_dwordx4 v1, s[40:43], s12 offen offset:2048 sc1 lds
    buffer_load_dwordx4 v1, s[40:43], s12 offen offset:3072 sc1 lds
    s_mov_b32 s12, 98304
    s_mov_b32 m0, s12
    s_nop 0
    buffer_load_dwordx4 v1, s[40:43], s12 offen offset:0 sc1 lds
    buffer_load_dwordx4 v1, s[40:43], s12 offen offset:1024 sc1 lds
    buffer_load_dwordx4 v1, s[40:43], s12 offen offset:2048 sc1 lds
    buffer_load_dwordx4 v1, s[40:43], s12 offen offset:3072 sc1 lds
    s_waitcnt vmcnt(24)
    s_barrier
    s_mov_b32 s12, 20480
    s_mov_b32 m0, s12
    s_nop 0
    buffer_load_dwordx4 v1, s[40:43], s12 offen offset:0 sc1 lds
    buffer_load_dwordx4 v1, s[40:43], s12 offen offset:1024 sc1 lds
    buffer_load_dwordx4 v1, s[40:43], s12 offen offset:2048 sc1 lds
    buffer_load_dwordx4 v1, s[40:43], s12 offen offset:3072 sc1 lds
    s_mov_b32 s12, 61440
    s_mov_b32 m0, s12
    s_nop 0
    buffer_load_dwordx4 v1, s[40:43], s12 offen offset:0 sc1 lds
    buffer_load_dwordx4 v1, s[40:43], s12 offen offset:1024 sc1 lds
    buffer_load_dwordx4 v1, s[40:43], s12 offen offset:2048 sc1 lds
    buffer_load_dwordx4 v1, s[40:43], s12 offen offset:3072 sc1 lds
    s_mov_b32 s12, 102400
    s_mov_b32 m0, s12
    s_nop 0
    buffer_load_dwordx4 v1, s[40:43], s12 offen offset:0 sc1 lds
    buffer_load_dwordx4 v1, s[40:43], s12 offen offset:1024 sc1 lds
    buffer_load_dwordx4 v1, s[40:43], s12 offen offset:2048 sc1 lds
    buffer_load_dwordx4 v1, s[40:43], s12 offen offset:3072 sc1 lds
    s_waitcnt vmcnt(24)
    s_barrier
    s_mov_b32 s12, 24576
    s_mov_b32 m0, s12
    s_nop 0
    buffer_load_dwordx4 v1, s[40:43], s12 offen offset:0 sc1 lds
    buffer_load_dwordx4 v1, s[40:43], s12 offen offset:1024 sc1 lds
    buffer_load_dwordx4 v1, s[40:43], s12 offen offset:2048 sc1 lds
    buffer_load_dwordx4 v1, s[40:43], s12 offen offset:3072 sc1 lds
    s_mov_b32 s12, 65536
    s_mov_b32 m0, s12
    s_nop 0
    buffer_load_dwordx4 v1, s[40:43], s12 offen offset:0 sc1 lds
    buffer_load_dwordx4 v1, s[40:43], s12 offen offset:1024 sc1 lds
    buffer_load_dwordx4 v1, s[40:43], s12 offen offset:2048 sc1 lds
    buffer_load_dwordx4 v1, s[40:43], s12 offen offset:3072 sc1 lds
    s_mov_b32 s12, 106496
    s_mov_b32 m0, s12
    s_nop 0
    buffer_load_dwordx4 v1, s[40:43], s12 offen offset:0 sc1 lds
    buffer_load_dwordx4 v1, s[40:43], s12 offen offset:1024 sc1 lds
    buffer_load_dwordx4 v1, s[40:43], s12 offen offset:2048 sc1 lds
    buffer_load_dwordx4 v1, s[40:43], s12 offen offset:3072 sc1 lds
    s_waitcnt vmcnt(24)
    s_barrier
    s_mov_b32 s12, 28672
    s_mov_b32 m0, s12
    s_nop 0
    buffer_load_dwordx4 v1, s[40:43], s12 offen offset:0 sc1 lds
    buffer_load_dwordx4 v1, s[40:43], s12 offen offset:1024 sc1 lds
    buffer_load_dwordx4 v1, s[40:43], s12 offen offset:2048 sc1 lds
    buffer_load_dwordx4 v1, s[40:43], s12 offen offset:3072 sc1 lds
    s_mov_b32 s12, 69632
    s_mov_b32 m0, s12
    s_nop 0
    buffer_load_dwordx4 v1, s[40:43], s12 offen offset:0 sc1 lds
    buffer_load_dwordx4 v1, s[40:43], s12 offen offset:1024 sc1 lds
    buffer_load_dwordx4 v1, s[40:43], s12 offen offset:2048 sc1 lds
    buffer_load_dwordx4 v1, s[40:43], s12 offen offset:3072 sc1 lds
    s_mov_b32 s12, 110592
    s_mov_b32 m0, s12
    s_nop 0
    buffer_load_dwordx4 v1, s[40:43], s12 offen offset:0 sc1 lds
    buffer_load_dwordx4 v1, s[40:43], s12 offen offset:1024 sc1 lds
    buffer_load_dwordx4 v1, s[40:43], s12 offen offset:2048 sc1 lds
    buffer_load_dwordx4 v1, s[40:43], s12 offen offset:3072 sc1 lds
    s_waitcnt vmcnt(24)
    s_barrier
    s_mov_b32 s12, 32768
    s_mov_b32 m0, s12
    s_nop 0
    buffer_load_dwordx4 v1, s[40:43], s12 offen offset:0 sc1 lds
    buffer_load_dwordx4 v1, s[40:43], s12 offen offset:1024 sc1 lds
    buffer_load_dwordx4 v1, s[40:43], s12 offen offset:2048 sc1 lds
    buffer_load_dwordx4 v1, s[40:43], s12 offen offset:3072 sc1 lds
    s_mov_b32 s12, 73728
    s_mov_b32 m0, s12
    s_nop 0
    buffer_load_dwordx4 v1, s[40:43], s12 offen offset:0 sc1 lds
    buffer_load_dwordx4 v1, s[40:43], s12 offen offset:1024 sc1 lds
    buffer_load_dwordx4 v1, s[40:43], s12 offen offset:2048 sc1 lds
    buffer_load_dwordx4 v1, s[40:43], s12 offen offset:3072 sc1 lds
    s_mov_b32 s12, 114688
    s_mov_b32 m0, s12
    s_nop 0
    buffer_load_dwordx4 v1, s[40:43], s12 offen offset:0 sc1 lds
    buffer_load_dwordx4 v1, s[40:43], s12 offen offset:1024 sc1 lds
    buffer_load_dwordx4 v1, s[40:43], s12 offen offset:2048 sc1 lds
    buffer_load_dwordx4 v1, s[40:43], s12 offen offset:3072 sc1 lds
    s_waitcnt vmcnt(24)
    s_barrier
    s_mov_b32 s12, 36864
    s_mov_b32 m0, s12
    s_nop 0
    buffer_load_dwordx4 v1, s[40:43], s12 offen offset:0 sc1 lds
    buffer_load_dwordx4 v1, s[40:43], s12 offen offset:1024 sc1 lds
    buffer_load_dwordx4 v1, s[40:43], s12 offen offset:2048 sc1 lds
    buffer_load_dwordx4 v1, s[40:43], s12 offen offset:3072 sc1 lds
    s_mov_b32 s12, 77824
    s_mov_b32 m0, s12
    s_nop 0
    buffer_load_dwordx4 v1, s[40:43], s12 offen offset:0 sc1 lds
    buffer_load_dwordx4 v1, s[40:43], s12 offen offset:1024 sc1 lds
    buffer_load_dwordx4 v1, s[40:43], s12 offen offset:2048 sc1 lds
    buffer_load_dwordx4 v1, s[40:43], s12 offen offset:3072 sc1 lds
    s_mov_b32 s12, 118784
    s_mov_b32 m0, s12
    s_nop 0
    buffer_load_dwordx4 v1, s[40:43], s12 offen offset:0 sc1 lds
    buffer_load_dwordx4 v1, s[40:43], s12 offen offset:1024 sc1 lds
    buffer_load_dwordx4 v1, s[40:43], s12 offen offset:2048 sc1 lds
    buffer_load_dwordx4 v1, s[40:43], s12 offen offset:3072 sc1 lds
    s_waitcnt vmcnt(24)
    s_barrier
    s_waitcnt vmcnt(12)
    s_barrier
    s_waitcnt vmcnt(0)
    s_barrier
L_end:
    s_endpgm
.section .rodata,"a"
.p2align 6
.amdhsa_kernel standalone__weight_only_int_quip__prompt_kernel
  .amdhsa_next_free_vgpr 256
  .amdhsa_next_free_sgpr 80
  .amdhsa_accum_offset 256
  .amdhsa_group_segment_fixed_size 0
  .amdhsa_float_denorm_mode_32 3
  .amdhsa_kernarg_size 72
  .amdhsa_user_sgpr_count 2
  .amdhsa_user_sgpr_kernarg_segment_ptr 1
  .amdhsa_system_sgpr_workgroup_id_x 1
.end_amdhsa_kernel
```
